```python
import torch

def _softmax(x, axis=-1):
    return torch.softmax(x, dim=axis)
def _gelu(x):
    return torch.nn.functional.gelu(x, approximate="tanh")
def _silu(x):
    return torch.nn.functional.silu(x)
def _sigmoid(x):
    return torch.sigmoid(x)
def _layernorm(x, axis=-1, eps=1e-5):
    m = x.mean(dim=axis, keepdim=True)
    v = x.var(dim=axis, keepdim=True, unbiased=False)
    return (x - m) / torch.sqrt(v + eps)
def _scatter_add(tgt, idx, src, axis=0):
    return tgt.clone().index_add_(axis, idx, src)
def _segment_sum(src, seg, n):
    out = torch.zeros((n,) + src.shape[1:], dtype=src.dtype)
    return out.index_add_(0, seg, src)
def _pad(x, pw):
    flat = tuple(v for pair in reversed(pw) for v in pair)
    return torch.nn.functional.pad(x, flat)

kernel_name = 'recurrent_scan__ssm_conv_s4d__moe_arch_mod__prompt'

def setup_inputs():

    _w = (lambda a: (lambda t: t.to(torch.bfloat16) if t.is_floating_point() else t)(torch.as_tensor(a)))
    def _A_setup():
        Bsz, L, D, N = 1, 2048, 448, 256
        return {
            "u": _w((lambda *s: torch.randn(*s, dtype=torch.bfloat16) * 0.05)(Bsz, L, D)),
            "log_A_real": _w((lambda *s: torch.randn(*s, dtype=torch.bfloat16) * 6.4)(D, N) * 0.5),
            "A_imag": _w((lambda *s: torch.randn(*s, dtype=torch.bfloat16) * 0.05)(D, N) * 3.14),
            "C_real": _w((lambda *s: torch.randn(*s, dtype=torch.bfloat16) * 0.05)(D, N) / N ** 0.5),
            "C_imag": _w((lambda *s: torch.randn(*s, dtype=torch.bfloat16) * 0.05)(D, N) / N ** 0.5),
            "log_dt": _w((lambda *s: torch.randn(*s, dtype=torch.bfloat16) * 0.05)(D) * 0.5 - 4.0),
            "D_skip": _w((lambda *s: torch.randn(*s, dtype=torch.bfloat16) * 0.05)(D)),
        }
    _A_in = _A_setup()

    def _B_setup():
        B, S, D, F, C = 1, 2048, 448, 1792, 2
        return {
            "x": _w((lambda *s: torch.randn(*s, dtype=torch.bfloat16) * 0.05)(B, S, D)),
            "w_r": _w((lambda *s: torch.randn(*s, dtype=torch.bfloat16) * 6.4)(D)),
            "w_gate": _w((lambda *s: torch.randn(*s, dtype=torch.bfloat16) * 0.1)(D, F)),
            "w_up": _w((lambda *s: torch.randn(*s, dtype=torch.bfloat16) * 0.1)(D, F)),
            "w_down": _w((lambda *s: torch.randn(*s, dtype=torch.bfloat16) * 0.1)(F, D)),
        }
    _B_in = _B_setup()

    return {
        "A_u": _A_in["u"],
        "A_log_A_real": _A_in["log_A_real"],
        "A_A_imag": _A_in["A_imag"],
        "A_C_real": _A_in["C_real"],
        "A_C_imag": _A_in["C_imag"],
        "A_log_dt": _A_in["log_dt"],
        "A_D_skip": _A_in["D_skip"],
        "B_x": _B_in["x"],
        "B_w_r": _B_in["w_r"],
        "B_w_gate": _B_in["w_gate"],
        "B_w_up": _B_in["w_up"],
        "B_w_down": _B_in["w_down"],
    }

def reference(A_u, A_log_A_real, A_A_imag, A_C_real, A_C_imag, A_log_dt, A_D_skip, B_x, B_w_r, B_w_gate, B_w_up, B_w_down):
    def _A_ref(u, log_A_real, A_imag, C_real, C_imag, log_dt, D_skip):
        L = u.shape[1]
        dt = torch.exp(log_dt)
        A = -torch.exp(log_A_real) + 1j * A_imag
        C = (C_real + 1j * C_imag) * dt[:, None]
        pos = (lambda x, dt: x.to(dt))(torch.arange(L), log_dt.dtype)
        P = torch.exp((A * dt[:, None])[:, :, None] * pos[None, None, :])
        K = 2.0 * torch.einsum("dn,dnl->dl", C, P).real
        L2 = 2 * L
        u_t = (lambda x, *d: x.permute(*d))(u, 0, 2, 1)
        Kf = (lambda x, *a, **k: torch.fft.rfft(x.float(), *a, **k))(K, L2)
        Uf = (lambda x, *a, **k: torch.fft.rfft(x.float(), *a, **k))(u_t, L2)
        y = (lambda x, *a, **k: torch.fft.irfft(x, *a, **k).to(torch.bfloat16))(Uf * Kf[None, :, :], L2)[:, :, :L]
        y = (lambda x, *d: x.permute(*d))(y, 0, 2, 1)
        return y + u * D_skip[None, None, :]

    def _B_ref(x, w_r, w_gate, w_up, w_down):
        B, S, D = x.shape
        C = 2
        r = x @ w_r
        idx = torch.argsort(-r, axis=-1)[:, :C]
        idx_e = (lambda x, n, axis: torch.repeat_interleave(x, n, dim=axis))(idx.reshape(B, C, 1), D, axis=2)
        x_sel = (lambda x, i, axis: torch.take_along_dim(x, i, dim=axis))(x, idx_e, axis=1)
        g = _silu(x_sel @ w_gate)
        u = x_sel @ w_up
        y = (g * u) @ w_down
        r_sel = _sigmoid((lambda x, i, axis: torch.take_along_dim(x, i, dim=axis))(r, idx, axis=1))
        y = y * r_sel.reshape(B, C, 1)
        b_off = (torch.arange(B) * S).reshape(B, 1)
        flat_idx = (idx + b_off).reshape(B * C)
        zero = (x * 0.0).reshape(B * S, D)
        upd = _scatter_add(zero, flat_idx, y.reshape(B * C, D), axis=0)
        return x + upd.reshape(B, S, D)

    x = A_u
    xn = _layernorm(x, axis=-1)
    s = _A_ref(xn, A_log_A_real, A_A_imag, A_C_real, A_C_imag, A_log_dt, A_D_skip)
    g = _silu(_B_ref(xn, B_w_r, B_w_gate, B_w_up, B_w_down))
    return x + s * g
```

```asm
; @launch grid=(256,1,1) block=(1024,1,1) lds=156416
.amdgcn_target "amdgcn-amd-amdhsa--gfx950"
.text
.globl recurrent_scan__ssm_conv_s4d__moe_arch_mod__prompt_kernel
.p2align 8
.type recurrent_scan__ssm_conv_s4d__moe_arch_mod__prompt_kernel,@function
recurrent_scan__ssm_conv_s4d__moe_arch_mod__prompt_kernel:
    s_cmp_ge_u32 s2, 256
    s_cbranch_scc1 L_end
    s_load_dwordx16 s[4:19], s[0:1], 0
    s_load_dwordx8 s[20:27], s[0:1], 64
    s_load_dwordx4 s[28:31], s[0:1], 96
    s_load_dwordx2 s[32:33], s[0:1], 112
    v_lshrrev_b32 v2, 6, v0
    v_and_b32 v1, 63, v0
    v_readfirstlane_b32 s34, v2
    s_and_b32 s52, s2, 3
    s_lshr_b32 s53, s2, 3
    s_lshl_b32 s54, s53, 2
    s_add_u32 s37, s54, s52
    s_lshl_b32 s54, s52, 5
    s_add_u32 s35, s54, s53
    s_mov_b32 s3, s35
    s_bitcmp1_b32 s2, 2
    s_cbranch_scc0 L_role_done
    s_mul_i32 s54, s52, 24
    s_add_u32 s54, s54, s53
    s_add_u32 s35, s54, 128
    s_movk_i32 s3, 128
    s_and_b32 s54, s2, 3
    s_lshl_b32 s54, s54, 3
    s_add_u32 s54, s54, s53
    s_sub_u32 s66, s54, 24
    s_cmp_ge_u32 s53, 24
    s_cbranch_scc1 L_moe
L_role_done:
    v_and_b32 v2, 511, v0
    v_lshlrev_b32 v2, 1, v2
    s_lshl_b32 s52, s35, 10
    v_add_u32 v2, s52, v2
    s_cmp_ge_u32 s34, 8
    s_cbranch_scc1 L_V
    s_cmp_ge_u32 s3, 128
    s_cbranch_scc1 L_nox_1
    s_lshl_b32 s52, s3, 4
    s_add_u32 s52, s52, s34
    s_mul_i32 s52, s52, 896
    v_and_b32 v6, 31, v1
    v_lshlrev_b32 v6, 4, v6
    v_lshrrev_b32 v3, 5, v1
    v_mul_u32_u24 v3, 7168, v3
    v_add3_u32 v3, s52, v6, v3
    v_mov_b32 v8, 0
    v_mov_b32 v9, 0
    v_mov_b32 v10, 0
    v_mov_b32 v11, 0
    v_mov_b32 v12, 0
    v_mov_b32 v13, 0
    v_mov_b32 v14, 0
    v_mov_b32 v15, 0
    v_mov_b32 v80, 0
    v_mov_b32 v81, 0
    v_mov_b32 v82, 0
    v_mov_b32 v83, 0
    v_mov_b32 v84, 0
    v_mov_b32 v85, 0
    v_mov_b32 v86, 0
    v_mov_b32 v87, 0
    s_waitcnt lgkmcnt(0)
    s_load_dword s36, s[32:33], 0
    s_mov_b32 exec_lo, 0x0fffffff
    s_mov_b32 exec_hi, 0x0fffffff
    global_load_dwordx4 v[8:11], v3, s[4:5]
    global_load_dwordx4 v[12:15], v3, s[4:5] offset:448
    global_load_dwordx4 v[80:83], v6, s[20:21]
    global_load_dwordx4 v[84:87], v6, s[20:21] offset:448
    s_mov_b64 exec, -1
    s_branch L_xj_2
L_nox_1:
    s_waitcnt lgkmcnt(0)
    s_load_dword s36, s[32:33], 0
L_xj_2:
    global_load_ushort v4, v2, s[6:7]
    global_load_ushort v5, v2, s[8:9]
    global_load_ushort v6, v2, s[10:11]
    global_load_ushort v7, v2, s[12:13]
    s_lshl_b32 s53, s35, 2
    s_load_dword s38, s[14:15], s53
    s_load_dword s39, s[16:17], s53
    s_cmp_lt_u32 s3, 128
    s_cbranch_scc1 L_nolate_3
    s_lshr_b32 s52, s2, 3
    s_mul_i32 s52, s52, 392
    s_and_b32 s53, s2, 3
    v_add_u32 v96, s52, v0
    s_movk_i32 s54, 3136
    s_movk_i32 s55, 6272
    v_cmp_le_u32 s[60:61], s54, v96
    v_cmp_le_u32 s[62:63], s55, v96
    v_subrev_u32 v97, s54, v96
    v_cndmask_b32 v96, v96, v97, s[60:61]
    v_subrev_u32 v97, s54, v96
    v_cndmask_b32 v96, v96, v97, s[62:63]
    v_mul_u32_u24 v97, 9363, v96
    v_lshrrev_b32 v97, 16, v97
    v_mul_u32_u24 v98, 7, v97
    v_sub_u32 v98, v96, v98
    v_mul_u32_u24 v97, 3584, v97
    v_lshl_add_u32 v97, v98, 7, v97
    s_mul_i32 s54, s53, 896
    v_add_u32 v97, s54, v97
    s_mul_i32 s55, s53, 401408
    v_lshlrev_b32 v98, 7, v96
    v_add_u32 v98, s55, v98
    v_cndmask_b32 v97, v97, v98, s[62:63]
    v_mov_b32 v102, s22
    v_mov_b32 v103, s23
    v_mov_b32 v98, s24
    v_mov_b32 v99, s25
    v_cndmask_b32 v102, v102, v98, s[60:61]
    v_cndmask_b32 v103, v103, v99, s[60:61]
    v_mov_b32 v98, s26
    v_mov_b32 v99, s27
    v_cndmask_b32 v102, v102, v98, s[62:63]
    v_cndmask_b32 v103, v103, v99, s[62:63]
    v_add_co_u32 v102, vcc, v102, v97
    s_nop 1
    v_addc_co_u32 v103, vcc, 0, v103, vcc
    v_cmp_gt_u32 vcc, 392, v0
    s_nop 0
    s_and_saveexec_b64 s[60:61], vcc
    s_cbranch_execz L_nowpf_4
    global_load_dword v104, v[102:103], off
L_nowpf_4:
    s_mov_b64 exec, s[60:61]
L_nolate_3:
    s_mov_b32 s40, s32
    s_and_b32 s41, s33, 0xffff
    s_mov_b32 s42, 0x00221000
    s_mov_b32 s43, 0x00020000
    s_mov_b32 s44, s28
    s_and_b32 s45, s29, 0xffff
    s_mov_b32 s46, 0x001c0000
    s_mov_b32 s47, 0x00020000
    s_lshr_b32 s52, s34, 2
    s_mul_i32 s54, s52, 16640
    s_add_u32 s54, s54, 110336
    v_and_b32 v20, 255, v0
    v_lshl_add_u32 v122, v20, 4, s54
    s_mul_i32 s52, s52, 2880
    s_add_u32 s52, s52, 111106
    v_lshlrev_b32 v20, 3, v20
    v_sub_u32 v20, 2051, v20
    v_cvt_f32_u32 v21, v20
    v_add_f32 v22, 0xbf800000, v21
    v_add_f32 v23, 0xc0000000, v21
    v_add_f32 v24, 0xc0400000, v21
    v_add_f32 v25, 0xc0800000, v21
    v_add_f32 v26, 0xc0a00000, v21
    v_add_f32 v27, 0xc0c00000, v21
    v_add_f32 v28, 0xc0e00000, v21
    v_add_f32 v29, 0xc1000000, v21
    v_add_f32 v30, 0xc1100000, v21
    v_add_f32 v31, 0xc1200000, v21
    v_cvt_pk_bf16_f32 v33, v21, v22
    v_cvt_pk_bf16_f32 v34, v23, v24
    v_cvt_pk_bf16_f32 v35, v25, v26
    v_cvt_pk_bf16_f32 v36, v27, v28
    v_cvt_pk_bf16_f32 v37, v29, v30
    v_cvt_pk_bf16_f32 v38, v31, v31
    v_and_b32 v40, 0xffff, v33
    v_lshl_add_u32 v105, v40, 1, s52
    v_lshrrev_b32 v41, 16, v33
    v_lshl_add_u32 v106, v41, 1, s52
    v_and_b32 v40, 0xffff, v34
    v_lshl_add_u32 v107, v40, 1, s52
    v_lshrrev_b32 v41, 16, v34
    v_lshl_add_u32 v108, v41, 1, s52
    v_and_b32 v40, 0xffff, v35
    v_lshl_add_u32 v109, v40, 1, s52
    v_lshrrev_b32 v41, 16, v35
    v_lshl_add_u32 v110, v41, 1, s52
    v_and_b32 v40, 0xffff, v36
    v_lshl_add_u32 v111, v40, 1, s52
    v_lshrrev_b32 v41, 16, v36
    v_lshl_add_u32 v112, v41, 1, s52
    v_and_b32 v40, 0xffff, v37
    v_lshl_add_u32 v113, v40, 1, s52
    v_lshrrev_b32 v41, 16, v37
    v_lshl_add_u32 v114, v41, 1, s52
    v_and_b32 v40, 0xffff, v38
    v_lshl_add_u32 v115, v40, 1, s52
    s_lshr_b32 s52, s34, 2
    s_mul_i32 s52, s52, 2880
    s_add_u32 s52, s52, 143616
    s_bfe_u32 s53, s34, 0x10001
    s_and_b32 s54, s34, 1
    v_lshrrev_b32 v20, 4, v1
    v_mov_b32 v21, 0
    v_mov_b32 v22, 1
    v_mov_b32 v23, 2
    v_cmp_eq_u32 vcc, 1, v20
    v_mov_b32 v24, 4
    v_mov_b32 v25, 1
    v_mov_b32 v26, 2
    v_cndmask_b32 v21, v21, v24, vcc
    v_cndmask_b32 v22, v22, v25, vcc
    v_cndmask_b32 v23, v23, v26, vcc
    v_cmp_eq_u32 vcc, 2, v20
    v_mov_b32 v24, 256
    v_mov_b32 v25, 2
    v_mov_b32 v26, 4
    v_cndmask_b32 v21, v21, v24, vcc
    v_cndmask_b32 v22, v22, v25, vcc
    v_cndmask_b32 v23, v23, v26, vcc
    v_cmp_eq_u32 vcc, 3, v20
    v_mov_b32 v24, 512
    v_mov_b32 v25, 4
    v_mov_b32 v26, 256
    v_cndmask_b32 v21, v21, v24, vcc
    v_cndmask_b32 v22, v22, v25, vcc
    v_cndmask_b32 v23, v23, v26, vcc
    s_mov_b32 s63, 64
    s_mov_b32 s57, 64
    s_cmp_eq_u32 s53, 0
    s_cbranch_scc1 L_ts_5
    v_cmp_eq_u32 vcc, 0, v20
    v_mov_b32 v21, 2048
    v_mov_b32 v24, 1024
    v_cndmask_b32 v21, v21, v24, vcc
    v_mov_b32 v22, 256
    v_mov_b32 v23, 512
    s_cmp_eq_u32 s54, 0
    s_cselect_b32 s63, 17, 16
    s_mov_b32 s57, 16
L_ts_5:
    v_and_b32 v24, 15, v1
    s_lshl_b32 s55, s54, 4
    v_add_u32 v24, s55, v24
    v_lshl_add_u32 v20, v24, 3, v21
    v_add_u32 v21, v20, v22
    v_add_u32 v25, v23, v22
    v_add_u32 v22, v20, v23
    v_add_u32 v23, v20, v25
    v_mov_b32 v26, s52
    v_add_u32 v26, 2840, v26
    v_cvt_f32_u32 v28, v20
    v_cvt_f32_u32 v29, v21
    v_cvt_f32_u32 v30, v22
    v_cvt_f32_u32 v31, v23
    v_lshrrev_b32 v28, 16, v28
    v_lshrrev_b32 v29, 16, v29
    v_lshrrev_b32 v30, 16, v30
    v_lshrrev_b32 v31, 16, v31
    s_movk_i32 s58, 0x3f7f
    v_sub_u32 v28, v28, s58 clamp
    v_sub_u32 v29, v29, s58 clamp
    v_sub_u32 v30, v30, s58 clamp
    v_sub_u32 v31, v31, s58 clamp
    v_lshl_add_u32 v28, v28, 1, s52
    v_lshl_add_u32 v29, v29, 1, s52
    v_lshl_add_u32 v30, v30, 1, s52
    v_lshl_add_u32 v31, v31, 1, s52
    v_cmp_le_u32 vcc, s63, v1
    s_nop 1
    v_cndmask_b32 v116, v28, v26, vcc
    v_cmp_le_u32 vcc, s57, v1
    s_nop 1
    v_cndmask_b32 v117, v29, v26, vcc
    v_cndmask_b32 v118, v30, v26, vcc
    v_cndmask_b32 v119, v31, v26, vcc
    v_and_b32 v20, 15, v1
    v_mul_u32_u24 v20, 2080, v20
    v_lshrrev_b32 v21, 4, v1
    v_lshl_add_u32 v20, v21, 4, v20
    s_lshr_b32 s55, s34, 2
    s_lshl_b32 s55, s55, 10
    s_mul_i32 s56, s53, 33280
    s_add_u32 s56, s56, s55
    v_add_u32 v120, s56, v20
    s_mul_i32 s56, s54, 33280
    s_add_u32 s56, s56, s55
    s_add_u32 s56, s56, 43680
    v_add_u32 v121, s56, v20
    s_mul_i32 s56, s34, 2368
    s_add_u32 s56, s56, 110336
    v_lshrrev_b32 v20, 5, v1
    v_mul_u32_u24 v20, 272, v20
    v_and_b32 v21, 31, v1
    v_lshl_add_u32 v20, v21, 3, v20
    v_add_u32 v123, s56, v20
    s_cmp_eq_u32 s34, 0
    s_cbranch_scc0 L_cz_6
    v_mov_b32 v20, 149568
    v_mov_b32 v22, 0
    v_mov_b32 v23, 0
    ds_write_b64 v20, v[22:23]
    ds_write_b64 v20, v[22:23] offset:8
    v_mov_b32 v20, 146464
    ds_write_b32 v20, v22
    ds_write_b32 v20, v22 offset:2880
L_cz_6:
    s_cmp_ge_u32 s34, 4
    s_cbranch_scc1 L_rp_7
    v_and_b32 v24, 15, v1
    v_lshrrev_b32 v25, 4, v1
    v_and_b32 v26, 3, v24
    v_mul_u32_u24 v26, 4160, v26
    v_lshrrev_b32 v27, 2, v24
    v_lshlrev_b32 v27, 3, v27
    v_lshl_add_u32 v26, v25, 4, v26
    v_sub_u32 v26, v26, v27
    s_lshr_b32 s52, s34, 1
    s_and_b32 s53, s34, 1
    s_mul_i32 s54, s52, 16640
    s_lshl_b32 s55, s53, 8
    s_sub_u32 s54, s54, s55
    s_add_u32 s54, s54, 110624
    v_add_u32 v96, s54, v26
    v_lshlrev_b32 v26, 5, v24
    v_lshl_add_u32 v26, v25, 4, v26
    s_mul_i32 s54, s52, 4672
    s_sub_u32 s54, s54, s55
    s_add_u32 s54, s54, 288
    v_add_u32 v97, s54, v26
    v_lshlrev_b32 v26, 4, v1
    s_lshl_b32 s54, s34, 11
    s_add_u32 s54, s54, 25856
    v_add_u32 v98, s54, v26
    v_lshrrev_b32 v26, 1, v1
    v_mul_u32_u24 v26, 7168, v26
    v_and_b32 v27, 1, v1
    v_lshl_add_u32 v99, v27, 4, v26
    s_branch L_rp_8
L_rp_7:
    s_sub_u32 s52, s34, 4
    s_lshr_b32 s57, s52, 2
    s_bfe_u32 s53, s52, 0x10001
    s_and_b32 s54, s52, 1
    v_and_b32 v26, 15, v1
    v_lshrrev_b32 v27, 4, v1
    v_lshlrev_b32 v26, 4, v26
    v_lshl_add_u32 v26, v27, 2, v26
    s_lshl_b32 s55, s53, 8
    s_lshl_b32 s56, s54, 1
    s_add_u32 s55, s55, s56
    s_lshl_b32 s56, s57, 9
    s_add_u32 s55, s55, s56
    v_add_u32 v26, s55, v26
    v_lshlrev_b32 v96, 1, v26
    v_mul_u32_u24 v97, 896, v26
    s_lshl_b32 s55, s53, 10
    s_lshl_b32 s56, s54, 3
    s_add_u32 s55, s55, s56
    s_lshl_b32 s56, s57, 13
    s_add_u32 s55, s55, s56
    s_add_u32 s55, s55, 25856
    v_lshl_add_u32 v98, v1, 4, s55
    s_and_b32 s55, s52, 3
    s_lshl_b32 s55, s55, 9
    s_lshl_b32 s56, s57, 11
    s_add_u32 s55, s55, s56
    s_add_u32 s55, s55, 17664
    v_lshl_add_u32 v99, v1, 3, s55
L_rp_8:
    s_waitcnt lgkmcnt(0)
    s_bfe_u32 s52, s34, 0x10002
    s_lshl_b32 s53, s38, 16
    s_and_b32 s54, s38, 0xffff0000
    s_cmp_eq_u32 s52, 0
    s_cselect_b32 s53, s53, s54
    v_mov_b32 v40, s53
    v_mul_f32 v42, 0x3fb8aa00, v40
    v_rndne_f32 v43, v42
    v_sub_f32 v42, v42, v43
    v_fmac_f32 v42, 0x36eca570, v40
    v_cvt_i32_f32 v43, v43
    v_exp_f32 v42, v42
    s_nop 0
    v_ldexp_f32 v41, v42, v43
    v_cvt_pk_bf16_f32 v126, 0, v41
    s_cmp_ge_u32 s3, 128
    s_cbranch_scc1 L_noln_9
    s_waitcnt vmcnt(0)
    s_setprio 2
    v_lshlrev_b32 v20, 16, v8
    v_and_b32 v21, 0xffff0000, v8
    v_lshlrev_b32 v22, 16, v9
    v_and_b32 v23, 0xffff0000, v9
    v_lshlrev_b32 v24, 16, v10
    v_and_b32 v25, 0xffff0000, v10
    v_lshlrev_b32 v26, 16, v11
    v_and_b32 v27, 0xffff0000, v11
    v_lshlrev_b32 v28, 16, v12
    v_and_b32 v29, 0xffff0000, v12
    v_lshlrev_b32 v30, 16, v13
    v_and_b32 v31, 0xffff0000, v13
    v_lshlrev_b32 v32, 16, v14
    v_and_b32 v33, 0xffff0000, v14
    v_lshlrev_b32 v34, 16, v15
    v_and_b32 v35, 0xffff0000, v15
    v_mov_b32 v66, 0
    v_mov_b32 v67, 0
    v_mov_b32 v68, 0x3f803f80
    v_dot2_f32_bf16 v66, v8, v80, v66
    v_dot2_f32_bf16 v66, v9, v81, v66
    v_dot2_f32_bf16 v66, v10, v82, v66
    v_dot2_f32_bf16 v66, v11, v83, v66
    v_dot2_f32_bf16 v66, v12, v84, v66
    v_dot2_f32_bf16 v66, v13, v85, v66
    v_dot2_f32_bf16 v66, v14, v86, v66
    v_dot2_f32_bf16 v66, v15, v87, v66
    v_permlane32_swap_b32 v8, v9
    v_permlane32_swap_b32 v10, v11
    v_permlane32_swap_b32 v12, v13
    v_permlane32_swap_b32 v14, v15
    s_mov_b32 exec_lo, 0x0fffffff
    s_mov_b32 exec_hi, 0x0fffffff
    ds_write2_b64 v123, v[8:9], v[10:11] offset0:0 offset1:68
    ds_write2_b64 v123, v[12:13], v[14:15] offset0:136 offset1:204
    s_mov_b64 exec, -1
    v_readlane_b32 s54, v20, 0
    v_readlane_b32 s55, v20, 32
    v_cmp_le_u32 s[62:63], 32, v1
    v_and_b32 v56, 31, v1
    v_cmp_gt_u32 vcc, 28, v56
    s_waitcnt lgkmcnt(0)
    s_barrier
    v_mov_b32 v36, s54
    v_mov_b32 v37, s55
    v_cndmask_b32 v57, v36, v37, s[62:63]
    v_cndmask_b32 v36, 0, v57, vcc
    v_pk_add_f32 v[40:41], v[20:21], v[36:37] op_sel_hi:[1,0] neg_lo:[0,1] neg_hi:[0,1]
    v_dot2_f32_bf16 v67, v80, v68, v67
    v_pk_add_f32 v[42:43], v[22:23], v[36:37] op_sel_hi:[1,0] neg_lo:[0,1] neg_hi:[0,1]
    v_dot2_f32_bf16 v67, v81, v68, v67
    v_pk_add_f32 v[44:45], v[24:25], v[36:37] op_sel_hi:[1,0] neg_lo:[0,1] neg_hi:[0,1]
    v_dot2_f32_bf16 v67, v82, v68, v67
    v_pk_add_f32 v[46:47], v[26:27], v[36:37] op_sel_hi:[1,0] neg_lo:[0,1] neg_hi:[0,1]
    v_dot2_f32_bf16 v67, v83, v68, v67
    v_pk_add_f32 v[48:49], v[28:29], v[36:37] op_sel_hi:[1,0] neg_lo:[0,1] neg_hi:[0,1]
    v_dot2_f32_bf16 v67, v84, v68, v67
    v_pk_add_f32 v[50:51], v[30:31], v[36:37] op_sel_hi:[1,0] neg_lo:[0,1] neg_hi:[0,1]
    v_dot2_f32_bf16 v67, v85, v68, v67
    v_pk_add_f32 v[52:53], v[32:33], v[36:37] op_sel_hi:[1,0] neg_lo:[0,1] neg_hi:[0,1]
    v_dot2_f32_bf16 v67, v86, v68, v67
    v_pk_add_f32 v[54:55], v[34:35], v[36:37] op_sel_hi:[1,0] neg_lo:[0,1] neg_hi:[0,1]
    v_dot2_f32_bf16 v67, v87, v68, v67
    v_pk_add_f32 v[58:59], v[40:41], v[42:43]
    v_pk_mul_f32 v[60:61], v[40:41], v[40:41]
    v_pk_add_f32 v[62:63], v[44:45], v[46:47]
    v_pk_mul_f32 v[64:65], v[42:43], v[42:43]
    v_pk_fma_f32 v[60:61], v[44:45], v[44:45], v[60:61]
    v_pk_fma_f32 v[64:65], v[46:47], v[46:47], v[64:65]
    v_pk_fma_f32 v[60:61], v[48:49], v[48:49], v[60:61]
    v_pk_fma_f32 v[64:65], v[50:51], v[50:51], v[64:65]
    v_pk_add_f32 v[58:59], v[58:59], v[48:49]
    v_pk_add_f32 v[62:63], v[62:63], v[50:51]
    v_pk_fma_f32 v[60:61], v[52:53], v[52:53], v[60:61]
    v_pk_fma_f32 v[64:65], v[54:55], v[54:55], v[64:65]
    v_pk_add_f32 v[58:59], v[58:59], v[52:53]
    v_pk_add_f32 v[62:63], v[62:63], v[54:55]
    v_pk_add_f32 v[58:59], v[58:59], v[62:63]
    v_pk_add_f32 v[60:61], v[60:61], v[64:65]
    v_add_f32 v58, v58, v59
    v_add_f32 v59, v60, v61
    s_nop 0
    v_add_f32_dpp v58, v58, v58 quad_perm:[1,0,3,2] row_mask:0xf bank_mask:0xf
    v_add_f32_dpp v59, v59, v59 quad_perm:[1,0,3,2] row_mask:0xf bank_mask:0xf
    v_add_f32_dpp v66, v66, v66 quad_perm:[1,0,3,2] row_mask:0xf bank_mask:0xf
    v_add_f32_dpp v67, v67, v67 quad_perm:[1,0,3,2] row_mask:0xf bank_mask:0xf
    v_add_f32_dpp v58, v58, v58 quad_perm:[2,3,0,1] row_mask:0xf bank_mask:0xf
    v_add_f32_dpp v59, v59, v59 quad_perm:[2,3,0,1] row_mask:0xf bank_mask:0xf
    v_add_f32_dpp v66, v66, v66 quad_perm:[2,3,0,1] row_mask:0xf bank_mask:0xf
    v_add_f32_dpp v67, v67, v67 quad_perm:[2,3,0,1] row_mask:0xf bank_mask:0xf
    v_add_f32_dpp v58, v58, v58 row_half_mirror row_mask:0xf bank_mask:0xf
    v_add_f32_dpp v59, v59, v59 row_half_mirror row_mask:0xf bank_mask:0xf
    v_add_f32_dpp v66, v66, v66 row_half_mirror row_mask:0xf bank_mask:0xf
    v_add_f32_dpp v67, v67, v67 row_half_mirror row_mask:0xf bank_mask:0xf
    v_add_f32_dpp v58, v58, v58 row_mirror row_mask:0xf bank_mask:0xf
    v_add_f32_dpp v59, v59, v59 row_mirror row_mask:0xf bank_mask:0xf
    v_add_f32_dpp v66, v66, v66 row_mirror row_mask:0xf bank_mask:0xf
    v_add_f32_dpp v67, v67, v67 row_mirror row_mask:0xf bank_mask:0xf
    v_mov_b32 v60, v58
    v_mov_b32 v61, v59
    v_mov_b32 v62, v66
    v_mov_b32 v63, v67
    v_permlane16_swap_b32 v58, v60
    v_permlane16_swap_b32 v59, v61
    v_permlane16_swap_b32 v66, v62
    v_permlane16_swap_b32 v67, v63
    v_add_f32 v58, v58, v60
    v_add_f32 v59, v59, v61
    v_add_f32 v66, v66, v62
    v_add_f32 v67, v67, v63
    s_mov_b32 s56, 0x3b124925
    v_mul_f32 v58, s56, v58
    v_mul_f32 v59, s56, v59
    v_fma_f32 v59, -v58, v58, v59
    v_add_f32 v58, v57, v58
    v_max_f32 v59, 0, v59
    v_cvt_pk_bf16_f32 v59, 0, v59
    v_cvt_pk_bf16_f32 v36, 0, v58
    v_add_f32 v59, 0x3727c5ac, v59
    v_lshrrev_b32 v62, 16, v36
    v_cvt_pk_bf16_f32 v59, 0, v59
    v_lshrrev_b32 v2, 5, v1
    v_lshlrev_b32 v63, 5, v2
    v_sqrt_f32 v59, v59
    s_lshl_b32 s56, s34, 2
    s_add_u32 s56, s56, 149376
    v_add_u32 v63, s56, v63
    v_lshlrev_b32 v65, 4, v2
    s_lshl_b32 s56, s34, 1
    s_add_u32 s56, s56, 149376
    v_add_u32 v65, s56, v65
    v_fma_f32 v66, -v36, v67, v66
    v_cvt_pk_bf16_f32 v59, 0, v59
    s_lshl_b32 s56, s3, 4
    s_add_u32 s56, s56, s34
    s_sub_u32 s56, 2047, s56
    v_rcp_f32 v38, v59
    v_mov_b32 v61, v62
    v_lshlrev_b32 v2, 3, v2
    v_sub_u32 v62, s56, v2
    v_fma_f32 v60, -v59, v38, 1.0
    v_fma_f32 v38, v60, v38, v38
    v_mul_f32 v60, v66, v38
    v_cvt_pk_bf16_f32 v60, v60, v60
    v_bfe_i32 v64, v60, 15, 1
    v_and_b32 v60, 0xffff, v60
    v_and_b32 v64, 0x7fff, v64
    v_or_b32 v64, 0x8000, v64
    v_xor_b32 v60, v60, v64
    v_lshl_or_b32 v60, v60, 16, v62
    s_mov_b32 exec_lo, 0x00000001
    s_mov_b32 exec_hi, 0x00000001
    ds_write_b16 v65, v61
    ds_write_b32 v63, v38 offset:32
    ds_write_b32 v63, v60 offset:96
    s_mov_b64 exec, -1
    s_waitcnt lgkmcnt(0)
    v_mov_b32 v2, 149568
    v_mov_b32 v3, 1
    s_mov_b64 exec, 1
    ds_add_u32 v2, v3
    s_mov_b64 exec, -1
    s_cmp_lt_u32 s34, 6
    s_cbranch_scc1 L_nopub_10
    s_add_u32 s59, s36, 1
    v_mov_b32 v2, 149568
    s_mov_b32 s61, 0
L_spin_12:
    ds_read_b32 v3, v2
    s_waitcnt lgkmcnt(0)
    v_readfirstlane_b32 s58, v3
    s_nop 0
    s_cmp_ge_u32 s58, 8
    s_cbranch_scc1 L_spinx_13
    s_add_u32 s61, s61, 1
    s_cmp_lt_u32 s61, 0x100000
    s_cbranch_scc1 L_spin_12
L_spinx_13:
    s_cmp_eq_u32 s34, 6
    s_cbranch_scc1 L_pub6_11
    v_and_b32 v2, 7, v1
    v_lshlrev_b32 v3, 2, v2
    v_add_u32 v3, 149376, v3
    v_lshlrev_b32 v92, 3, v2
    v_add_u32 v92, 149408, v92
    ds_read_b32 v88, v3
    ds_read_b64 v[90:91], v92
    v_lshlrev_b32 v2, 4, v2
    s_lshl_b32 s57, s3, 7
    s_add_u32 s57, s57, 1970176
    s_waitcnt lgkmcnt(0)
    v_mov_b32 v89, v90
    v_mov_b32 v90, v91
    v_mov_b32 v91, s59
    s_mov_b64 exec, 0xff
    buffer_store_dwordx4 v[88:91], v2, s[40:43], s57 offen sc1
    s_mov_b64 exec, -1
    s_branch L_nopub_10
L_pub6_11:
    v_and_b32 v2, 15, v1
    v_lshlrev_b32 v2, 2, v2
    v_add_u32 v2, 149472, v2
    ds_read_b32 v88, v2
    s_mul_i32 s57, s3, 64
    s_add_u32 s57, s57, 1953792
    s_waitcnt lgkmcnt(0)
    v_mov_b32 v92, v88
    s_nop 1
    v_max_u32_dpp v92, v92, v92 quad_perm:[1,0,3,2] row_mask:0xf bank_mask:0xf
    s_nop 1
    v_max_u32_dpp v92, v92, v92 quad_perm:[2,3,0,1] row_mask:0xf bank_mask:0xf
    s_nop 1
    v_max_u32_dpp v92, v92, v92 row_half_mirror row_mask:0xf bank_mask:0xf
    s_nop 1
    v_max_u32_dpp v92, v92, v92 row_mirror row_mask:0xf bank_mask:0xf
    v_cmp_eq_u32 vcc, v92, v88
    s_nop 1
    v_cndmask_b32 v93, v88, 0, vcc
    s_nop 1
    v_max_u32_dpp v93, v93, v93 quad_perm:[1,0,3,2] row_mask:0xf bank_mask:0xf
    s_nop 1
    v_max_u32_dpp v93, v93, v93 quad_perm:[2,3,0,1] row_mask:0xf bank_mask:0xf
    s_nop 1
    v_max_u32_dpp v93, v93, v93 row_half_mirror row_mask:0xf bank_mask:0xf
    s_nop 1
    v_max_u32_dpp v93, v93, v93 row_mirror row_mask:0xf bank_mask:0xf
    v_mov_b32 v94, 0
    v_mov_b32 v95, s59
    v_mov_b32 v2, 0
    s_mov_b64 exec, 1
    buffer_store_dwordx4 v[92:95], v2, s[40:43], s57 offen sc1
    s_mov_b64 exec, -1
L_nopub_10:
    s_setprio 0
    s_branch L_lnj_14
L_noln_9:
    s_waitcnt vmcnt(1)
    s_cmp_lt_u32 s34, 7
    s_cbranch_scc1 L_uw_15
    s_waitcnt vmcnt(0)
L_uw_15:
    s_waitcnt lgkmcnt(0)
L_lnj_14:
    s_waitcnt lgkmcnt(0)
    s_add_u32 s36, s36, 1
    v_lshlrev_b32 v4, 16, v4
    v_lshlrev_b32 v5, 16, v5
    v_mul_f32 v13, 0x3fb8aa00, v4
    v_rndne_f32 v14, v13
    v_sub_f32 v13, v13, v14
    v_fmac_f32 v13, 0x36eca570, v4
    v_cvt_i32_f32 v14, v14
    v_exp_f32 v13, v13
    s_nop 0
    v_ldexp_f32 v12, v13, v14
    v_mul_f32 v13, v126, v5
    v_mov_b32 v10, v126
    v_cvt_pk_bf16_f32 v11, 0, v12
    v_mul_f32 v13, 0x3e22f983, v13
    v_mul_f32 v12, v10, v11
    v_mul_f32 v12, 0xbfb8aa3b, v12
    v_lshlrev_b32 v6, 16, v6
    v_lshlrev_b32 v7, 16, v7
    v_mul_f32 v16, v10, v6
    v_mul_f32 v17, v10, v7
    v_add_f32 v16, v16, v16
    v_add_f32 v17, v17, v17
    v_exp_f32 v40, v12
    v_fract_f32 v41, v13
    v_mul_f32 v44, 0x43800000, v12
    v_mul_f32 v45, 0x43800000, v13
    v_exp_f32 v44, v44
    v_fract_f32 v45, v45
    v_cos_f32 v42, v41
    v_sin_f32 v43, v41
    v_cos_f32 v46, v45
    v_sin_f32 v47, v45
    v_mul_f32 v20, v40, v42
    v_mul_f32 v21, v40, v43
    v_mul_f32 v22, v44, v46
    v_mul_f32 v23, v44, v47
    s_lshl_b32 s52, s34, 8
    s_mov_b32 m0, s52
    v_cvt_pk_bf16_f32 v56, v16, -v17
    ds_write_addtid_b32 v56 offset:0
    v_pk_mul_f32 v[60:61], v[20:21], v[20:21] op_sel:[1,1] op_sel_hi:[1,0] neg_lo:[1,0]
    v_pk_fma_f32 v[24:25], v[20:21], v[20:21], v[60:61] op_sel:[0,0,0] op_sel_hi:[0,1,1]
    v_pk_mul_f32 v[62:63], v[22:23], v[22:23] op_sel:[1,1] op_sel_hi:[1,0] neg_lo:[1,0]
    v_pk_fma_f32 v[28:29], v[22:23], v[22:23], v[62:63] op_sel:[0,0,0] op_sel_hi:[0,1,1]
    v_pk_mul_f32 v[60:61], v[16:17], v[20:21] op_sel:[1,1] op_sel_hi:[1,0] neg_lo:[1,0]
    v_pk_fma_f32 v[30:31], v[16:17], v[20:21], v[60:61] op_sel:[0,0,0] op_sel_hi:[0,1,1]
    v_pk_mul_f32 v[62:63], v[16:17], v[22:23] op_sel:[1,1] op_sel_hi:[1,0] neg_lo:[1,0]
    v_pk_fma_f32 v[32:33], v[16:17], v[22:23], v[62:63] op_sel:[0,0,0] op_sel_hi:[0,1,1]
    v_cvt_pk_bf16_f32 v57, v30, -v31
    ds_write_addtid_b32 v57 offset:2080
    v_cvt_pk_bf16_f32 v58, v32, -v33
    ds_write_addtid_b32 v58 offset:16640
    v_pk_mul_f32 v[60:61], v[24:25], v[24:25] op_sel:[1,1] op_sel_hi:[1,0] neg_lo:[1,0]
    v_pk_fma_f32 v[26:27], v[24:25], v[24:25], v[60:61] op_sel:[0,0,0] op_sel_hi:[0,1,1]
    v_pk_mul_f32 v[62:63], v[16:17], v[28:29] op_sel:[1,1] op_sel_hi:[1,0] neg_lo:[1,0]
    v_pk_fma_f32 v[34:35], v[16:17], v[28:29], v[62:63] op_sel:[0,0,0] op_sel_hi:[0,1,1]
    v_pk_mul_f32 v[60:61], v[30:31], v[20:21] op_sel:[1,1] op_sel_hi:[1,0] neg_lo:[1,0]
    v_pk_fma_f32 v[30:31], v[30:31], v[20:21], v[60:61] op_sel:[0,0,0] op_sel_hi:[0,1,1]
    v_pk_mul_f32 v[62:63], v[32:33], v[24:25] op_sel:[1,1] op_sel_hi:[1,0] neg_lo:[1,0]
    v_pk_fma_f32 v[32:33], v[32:33], v[24:25], v[62:63] op_sel:[0,0,0] op_sel_hi:[0,1,1]
    v_cvt_pk_bf16_f32 v59, v34, -v35
    ds_write_addtid_b32 v59 offset:24960
    v_cvt_pk_bf16_f32 v56, v30, -v31
    ds_write_addtid_b32 v56 offset:4160
    v_cvt_pk_bf16_f32 v57, v32, -v33
    ds_write_addtid_b32 v57 offset:18720
    v_pk_mul_f32 v[60:61], v[34:35], v[28:29] op_sel:[1,1] op_sel_hi:[1,0] neg_lo:[1,0]
    v_pk_fma_f32 v[36:37], v[34:35], v[28:29], v[60:61] op_sel:[0,0,0] op_sel_hi:[0,1,1]
    v_pk_mul_f32 v[62:63], v[30:31], v[20:21] op_sel:[1,1] op_sel_hi:[1,0] neg_lo:[1,0]
    v_pk_fma_f32 v[30:31], v[30:31], v[20:21], v[62:63] op_sel:[0,0,0] op_sel_hi:[0,1,1]
    v_pk_mul_f32 v[60:61], v[32:33], v[24:25] op_sel:[1,1] op_sel_hi:[1,0] neg_lo:[1,0]
    v_pk_fma_f32 v[32:33], v[32:33], v[24:25], v[60:61] op_sel:[0,0,0] op_sel_hi:[0,1,1]
    v_pk_mul_f32 v[62:63], v[34:35], v[26:27] op_sel:[1,1] op_sel_hi:[1,0] neg_lo:[1,0]
    v_pk_fma_f32 v[38:39], v[34:35], v[26:27], v[62:63] op_sel:[0,0,0] op_sel_hi:[0,1,1]
    v_cvt_pk_bf16_f32 v58, v36, -v37
    ds_write_addtid_b32 v58 offset:33280
    v_cvt_pk_bf16_f32 v59, v30, -v31
    ds_write_addtid_b32 v59 offset:6240
    v_cvt_pk_bf16_f32 v56, v32, -v33
    ds_write_addtid_b32 v56 offset:20800
    v_cvt_pk_bf16_f32 v57, v38, -v39
    ds_write_addtid_b32 v57 offset:27040
    v_pk_mul_f32 v[60:61], v[34:35], v[22:23] op_sel:[1,1] op_sel_hi:[1,0] neg_lo:[1,0]
    v_pk_fma_f32 v[34:35], v[34:35], v[22:23], v[60:61] op_sel:[0,0,0] op_sel_hi:[0,1,1]
    v_pk_mul_f32 v[62:63], v[30:31], v[20:21] op_sel:[1,1] op_sel_hi:[1,0] neg_lo:[1,0]
    v_pk_fma_f32 v[30:31], v[30:31], v[20:21], v[62:63] op_sel:[0,0,0] op_sel_hi:[0,1,1]
    v_pk_mul_f32 v[60:61], v[32:33], v[24:25] op_sel:[1,1] op_sel_hi:[1,0] neg_lo:[1,0]
    v_pk_fma_f32 v[32:33], v[32:33], v[24:25], v[60:61] op_sel:[0,0,0] op_sel_hi:[0,1,1]
    v_pk_mul_f32 v[62:63], v[36:37], v[22:23] op_sel:[1,1] op_sel_hi:[1,0] neg_lo:[1,0]
    v_pk_fma_f32 v[36:37], v[36:37], v[22:23], v[62:63] op_sel:[0,0,0] op_sel_hi:[0,1,1]
    v_cvt_pk_bf16_f32 v58, v34, -v35
    ds_write_addtid_b32 v58 offset:29120
    v_cvt_pk_bf16_f32 v59, v30, -v31
    ds_write_addtid_b32 v59 offset:8320
    v_cvt_pk_bf16_f32 v56, v32, -v33
    ds_write_addtid_b32 v56 offset:22880
    v_cvt_pk_bf16_f32 v57, v36, -v37
    ds_write_addtid_b32 v57 offset:35360
    v_pk_mul_f32 v[60:61], v[34:35], v[26:27] op_sel:[1,1] op_sel_hi:[1,0] neg_lo:[1,0]
    v_pk_fma_f32 v[34:35], v[34:35], v[26:27], v[60:61] op_sel:[0,0,0] op_sel_hi:[0,1,1]
    v_pk_mul_f32 v[62:63], v[30:31], v[20:21] op_sel:[1,1] op_sel_hi:[1,0] neg_lo:[1,0]
    v_pk_fma_f32 v[30:31], v[30:31], v[20:21], v[62:63] op_sel:[0,0,0] op_sel_hi:[0,1,1]
    v_pk_mul_f32 v[60:61], v[36:37], v[22:23] op_sel:[1,1] op_sel_hi:[1,0] neg_lo:[1,0]
    v_pk_fma_f32 v[36:37], v[36:37], v[22:23], v[60:61] op_sel:[0,0,0] op_sel_hi:[0,1,1]
    v_cvt_pk_bf16_f32 v58, v34, -v35
    ds_write_addtid_b32 v58 offset:31200
    v_cvt_pk_bf16_f32 v59, v30, -v31
    ds_write_addtid_b32 v59 offset:10400
    v_cvt_pk_bf16_f32 v56, v36, -v37
    ds_write_addtid_b32 v56 offset:37440
    v_pk_mul_f32 v[62:63], v[30:31], v[20:21] op_sel:[1,1] op_sel_hi:[1,0] neg_lo:[1,0]
    v_pk_fma_f32 v[30:31], v[30:31], v[20:21], v[62:63] op_sel:[0,0,0] op_sel_hi:[0,1,1]
    v_pk_mul_f32 v[60:61], v[36:37], v[22:23] op_sel:[1,1] op_sel_hi:[1,0] neg_lo:[1,0]
    v_pk_fma_f32 v[36:37], v[36:37], v[22:23], v[60:61] op_sel:[0,0,0] op_sel_hi:[0,1,1]
    v_cvt_pk_bf16_f32 v57, v30, -v31
    ds_write_addtid_b32 v57 offset:12480
    v_cvt_pk_bf16_f32 v58, v36, -v37
    ds_write_addtid_b32 v58 offset:39520
    v_pk_mul_f32 v[62:63], v[30:31], v[20:21] op_sel:[1,1] op_sel_hi:[1,0] neg_lo:[1,0]
    v_pk_fma_f32 v[30:31], v[30:31], v[20:21], v[62:63] op_sel:[0,0,0] op_sel_hi:[0,1,1]
    v_pk_mul_f32 v[60:61], v[36:37], v[22:23] op_sel:[1,1] op_sel_hi:[1,0] neg_lo:[1,0]
    v_pk_fma_f32 v[36:37], v[36:37], v[22:23], v[60:61] op_sel:[0,0,0] op_sel_hi:[0,1,1]
    v_cvt_pk_bf16_f32 v59, v30, -v31
    ds_write_addtid_b32 v59 offset:14560
    v_cvt_pk_bf16_f32 v56, v36, -v37
    ds_write_addtid_b32 v56 offset:41600
    s_waitcnt lgkmcnt(0)
    s_barrier
    ds_read_b128 v[16:19], v120 offset:0
    ds_read_b128 v[40:43], v121 offset:0
    ds_read_b128 v[20:23], v120 offset:64
    ds_read_b128 v[44:47], v121 offset:64
    ds_read_b128 v[24:27], v120 offset:128
    ds_read_b128 v[48:51], v121 offset:128
    ds_read_b128 v[28:31], v120 offset:192
    ds_read_b128 v[52:55], v121 offset:192
    ds_read_b128 v[32:35], v120 offset:256
    ds_read_b128 v[56:59], v121 offset:256
    s_waitcnt lgkmcnt(8)
    v_mfma_f32_16x16x32_bf16 v[64:67], v[16:19], v[40:43], 0
    ds_read_b128 v[36:39], v120 offset:320
    ds_read_b128 v[60:63], v121 offset:320
    s_waitcnt lgkmcnt(8)
    v_mfma_f32_16x16x32_bf16 v[64:67], v[20:23], v[44:47], v[64:67]
    ds_read_b128 v[16:19], v120 offset:384
    ds_read_b128 v[40:43], v121 offset:384
    s_waitcnt lgkmcnt(8)
    v_mfma_f32_16x16x32_bf16 v[64:67], v[24:27], v[48:51], v[64:67]
    ds_read_b128 v[20:23], v120 offset:448
    ds_read_b128 v[44:47], v121 offset:448
    s_waitcnt lgkmcnt(8)
    v_mfma_f32_16x16x32_bf16 v[64:67], v[28:31], v[52:55], v[64:67]
    ds_read_b128 v[24:27], v120 offset:512
    ds_read_b128 v[48:51], v121 offset:512
    s_waitcnt lgkmcnt(8)
    v_mfma_f32_16x16x32_bf16 v[64:67], v[32:35], v[56:59], v[64:67]
    ds_read_b128 v[28:31], v120 offset:576
    ds_read_b128 v[52:55], v121 offset:576
    s_waitcnt lgkmcnt(8)
    v_mfma_f32_16x16x32_bf16 v[64:67], v[36:39], v[60:63], v[64:67]
    ds_read_b128 v[32:35], v120 offset:640
    ds_read_b128 v[56:59], v121 offset:640
    s_waitcnt lgkmcnt(8)
    v_mfma_f32_16x16x32_bf16 v[64:67], v[16:19], v[40:43], v[64:67]
    ds_read_b128 v[36:39], v120 offset:704
    ds_read_b128 v[60:63], v121 offset:704
    s_waitcnt lgkmcnt(8)
    v_mfma_f32_16x16x32_bf16 v[64:67], v[20:23], v[44:47], v[64:67]
    ds_read_b128 v[16:19], v120 offset:768
    ds_read_b128 v[40:43], v121 offset:768
    s_waitcnt lgkmcnt(8)
    v_mfma_f32_16x16x32_bf16 v[64:67], v[24:27], v[48:51], v[64:67]
    ds_read_b128 v[20:23], v120 offset:832
    ds_read_b128 v[44:47], v121 offset:832
    s_waitcnt lgkmcnt(8)
    v_mfma_f32_16x16x32_bf16 v[64:67], v[28:31], v[52:55], v[64:67]
    ds_read_b128 v[24:27], v120 offset:896
    ds_read_b128 v[48:51], v121 offset:896
    s_waitcnt lgkmcnt(8)
    v_mfma_f32_16x16x32_bf16 v[64:67], v[32:35], v[56:59], v[64:67]
    ds_read_b128 v[28:31], v120 offset:960
    ds_read_b128 v[52:55], v121 offset:960
    s_waitcnt lgkmcnt(8)
    v_mfma_f32_16x16x32_bf16 v[64:67], v[36:39], v[60:63], v[64:67]
    s_waitcnt lgkmcnt(6)
    v_mfma_f32_16x16x32_bf16 v[64:67], v[16:19], v[40:43], v[64:67]
    s_waitcnt lgkmcnt(4)
    v_mfma_f32_16x16x32_bf16 v[64:67], v[20:23], v[44:47], v[64:67]
    s_waitcnt lgkmcnt(2)
    v_mfma_f32_16x16x32_bf16 v[64:67], v[24:27], v[48:51], v[64:67]
    s_waitcnt lgkmcnt(0)
    v_mfma_f32_16x16x32_bf16 v[64:67], v[28:31], v[52:55], v[64:67]
    s_nop 7
    v_cvt_pk_bf16_f32 v20, v64, v65
    v_cvt_pk_bf16_f32 v21, v66, v67
    ds_write_b16 v116, v20
    ds_write_b16_d16_hi v117, v20
    ds_write_b16 v118, v21
    ds_write_b16_d16_hi v119, v21
    s_waitcnt lgkmcnt(0)
    v_mov_b32 v2, 149576
    v_mov_b32 v3, 1
    s_mov_b64 exec, 1
    ds_add_u32 v2, v3
    s_mov_b64 exec, -1
    v_mov_b32 v2, 149576
    s_mov_b32 s61, 0
L_spin_16:
    ds_read_b32 v3, v2
    s_waitcnt lgkmcnt(0)
    v_readfirstlane_b32 s58, v3
    s_nop 0
    s_cmp_ge_u32 s58, 8
    s_cbranch_scc1 L_spinx_17
    s_add_u32 s61, s61, 1
    s_cmp_lt_u32 s61, 0x100000
    s_cbranch_scc1 L_spin_16
L_spinx_17:
    ds_read_u16 v16, v105
    ds_read_u16 v17, v106
    ds_read_u16 v18, v107
    ds_read_u16 v19, v108
    ds_read_u16 v20, v109
    ds_read_u16 v21, v110
    ds_read_u16 v22, v111
    ds_read_u16 v23, v112
    ds_read_u16 v24, v113
    ds_read_u16 v25, v114
    ds_read_u16 v26, v115
    s_waitcnt lgkmcnt(3)
    v_lshl_or_b32 v28, v17, 16, v16
    v_lshl_or_b32 v29, v19, 16, v18
    v_lshl_or_b32 v30, v21, 16, v20
    v_lshl_or_b32 v31, v23, 16, v22
    ds_write_b128 v122, v[28:31] offset:12480
    s_waitcnt lgkmcnt(3)
    v_lshl_or_b32 v32, v18, 16, v17
    v_lshl_or_b32 v33, v20, 16, v19
    v_lshl_or_b32 v34, v22, 16, v21
    v_lshl_or_b32 v35, v24, 16, v23
    ds_write_b128 v122, v[32:35] offset:8320
    s_waitcnt lgkmcnt(3)
    v_lshl_or_b32 v36, v19, 16, v18
    v_lshl_or_b32 v37, v21, 16, v20
    v_lshl_or_b32 v38, v23, 16, v22
    v_lshl_or_b32 v39, v25, 16, v24
    ds_write_b128 v122, v[36:39] offset:4160
    s_waitcnt lgkmcnt(3)
    v_lshl_or_b32 v40, v20, 16, v19
    v_lshl_or_b32 v41, v22, 16, v21
    v_lshl_or_b32 v42, v24, 16, v23
    v_lshl_or_b32 v43, v26, 16, v25
    ds_write_b128 v122, v[40:43] offset:0
    s_cmp_ge_u32 s34, 4
    s_cbranch_scc1 L_epi
    s_lshl_b32 s60, s35, 5
    s_add_u32 s60, s60, 1986560
    s_waitcnt lgkmcnt(0)
    s_barrier
    s_setprio 1
    ds_read_b128 v[16:19], v97 offset:704
    ds_read_b64 v[20:21], v96 offset:3776
    ds_read_b64 v[22:23], v96 offset:3784
    ds_read_b128 v[24:27], v97 offset:192
    ds_read_b64 v[28:29], v96 offset:3264
    ds_read_b64 v[30:31], v96 offset:3272
    ds_read_b128 v[32:35], v97 offset:640
    ds_read_b64 v[36:37], v96 offset:3712
    ds_read_b64 v[38:39], v96 offset:3720
    ds_read_b128 v[40:43], v97 offset:128
    ds_read_b64 v[44:45], v96 offset:3200
    ds_read_b64 v[46:47], v96 offset:3208
    ds_read_b128 v[48:51], v97 offset:576
    ds_read_b64 v[52:53], v96 offset:3648
    ds_read_b64 v[54:55], v96 offset:3656
    s_waitcnt lgkmcnt(11)
    v_mfma_f32_16x16x32_bf16 v[84:87], v[20:23], v[16:19], 0
    ds_read_b128 v[56:59], v97 offset:64
    ds_read_b64 v[60:61], v96 offset:3136
    v_mfma_f32_16x16x32_bf16 v[80:83], v[20:23], v[24:27], 0
    ds_read_b64 v[62:63], v96 offset:3144
    s_waitcnt lgkmcnt(12)
    v_mfma_f32_16x16x32_bf16 v[84:87], v[28:31], v[24:27], v[84:87]
    ds_read_b128 v[64:67], v97 offset:512
    ds_read_b64 v[68:69], v96 offset:3584
    s_waitcnt lgkmcnt(10)
    v_mfma_f32_16x16x32_bf16 v[84:87], v[36:39], v[32:35], v[84:87]
    ds_read_b64 v[70:71], v96 offset:3592
    ds_read_b128 v[72:75], v97 offset:0
    v_mfma_f32_16x16x32_bf16 v[80:83], v[36:39], v[40:43], v[80:83]
    ds_read_b64 v[76:77], v96 offset:3072
    ds_read_b64 v[78:79], v96 offset:3080
    s_waitcnt lgkmcnt(12)
    v_mfma_f32_16x16x32_bf16 v[84:87], v[44:47], v[40:43], v[84:87]
    ds_read_b128 v[16:19], v97 offset:1728
    ds_read_b64 v[20:21], v96 offset:3776
    s_waitcnt lgkmcnt(10)
    v_mfma_f32_16x16x32_bf16 v[84:87], v[52:55], v[48:51], v[84:87]
    ds_read_b64 v[22:23], v96 offset:3784
    ds_read_b128 v[28:31], v97 offset:1216
    v_mfma_f32_16x16x32_bf16 v[80:83], v[52:55], v[56:59], v[80:83]
    ds_read_b64 v[24:25], v96 offset:3264
    ds_read_b64 v[26:27], v96 offset:3272
    s_waitcnt lgkmcnt(12)
    v_mfma_f32_16x16x32_bf16 v[84:87], v[60:63], v[56:59], v[84:87]
    ds_read_b128 v[32:35], v97 offset:704
    ds_read_b64 v[36:37], v96 offset:2752
    s_waitcnt lgkmcnt(10)
    v_mfma_f32_16x16x32_bf16 v[84:87], v[68:71], v[64:67], v[84:87]
    ds_read_b64 v[38:39], v96 offset:2760
    ds_read_b128 v[44:47], v97 offset:192
    v_mfma_f32_16x16x32_bf16 v[80:83], v[68:71], v[72:75], v[80:83]
    ds_read_b64 v[40:41], v96 offset:2240
    ds_read_b64 v[42:43], v96 offset:2248
    s_waitcnt lgkmcnt(12)
    v_mfma_f32_16x16x32_bf16 v[84:87], v[76:79], v[72:75], v[84:87]
    ds_read_b128 v[48:51], v97 offset:1664
    ds_read_b64 v[52:53], v96 offset:3712
    s_nop 1
    ds_write_b128 v98, v[80:83] offset:0
    s_waitcnt lgkmcnt(14)
    s_nop 1
    ds_write_b128 v98, v[84:87] offset:1024
    s_waitcnt lgkmcnt(0)
    s_barrier
    v_mfma_f32_16x16x32_bf16 v[92:95], v[20:23], v[16:19], 0
    ds_read_b64 v[54:55], v96 offset:3720
    ds_read_b128 v[60:63], v97 offset:1152
    v_mfma_f32_16x16x32_bf16 v[88:91], v[20:23], v[28:31], 0
    ds_read_b64 v[56:57], v96 offset:3200
    ds_read_b64 v[58:59], v96 offset:3208
    v_mfma_f32_16x16x32_bf16 v[92:95], v[24:27], v[28:31], v[92:95]
    ds_read_b128 v[64:67], v97 offset:640
    ds_read_b64 v[68:69], v96 offset:2688
    v_mfma_f32_16x16x32_bf16 v[88:91], v[24:27], v[32:35], v[88:91]
    ds_read_b64 v[70:71], v96 offset:2696
    ds_read_b128 v[76:79], v97 offset:128
    v_mfma_f32_16x16x32_bf16 v[92:95], v[36:39], v[32:35], v[92:95]
    ds_read_b64 v[72:73], v96 offset:2176
    ds_read_b64 v[74:75], v96 offset:2184
    v_mfma_f32_16x16x32_bf16 v[88:91], v[36:39], v[44:47], v[88:91]
    ds_read_b128 v[16:19], v97 offset:1600
    ds_read_b64 v[20:21], v96 offset:3648
    v_mfma_f32_16x16x32_bf16 v[92:95], v[40:43], v[44:47], v[92:95]
    ds_read_b64 v[22:23], v96 offset:3656
    ds_read_b128 v[28:31], v97 offset:1088
    s_waitcnt lgkmcnt(12)
    v_mfma_f32_16x16x32_bf16 v[92:95], v[52:55], v[48:51], v[92:95]
    ds_read_b64 v[24:25], v96 offset:3136
    ds_read_b64 v[26:27], v96 offset:3144
    v_mfma_f32_16x16x32_bf16 v[88:91], v[52:55], v[60:63], v[88:91]
    s_waitcnt lgkmcnt(11)
    v_mfma_f32_16x16x32_bf16 v[92:95], v[56:59], v[60:63], v[92:95]
    ds_read_b128 v[32:35], v97 offset:576
    ds_read_b64 v[36:37], v96 offset:2624
    v_mfma_f32_16x16x32_bf16 v[88:91], v[56:59], v[64:67], v[88:91]
    ds_read_b64 v[38:39], v96 offset:2632
    s_waitcnt lgkmcnt(11)
    v_mfma_f32_16x16x32_bf16 v[92:95], v[68:71], v[64:67], v[92:95]
    ds_read_b128 v[40:43], v97 offset:64
    ds_read_b64 v[44:45], v96 offset:2112
    v_mfma_f32_16x16x32_bf16 v[88:91], v[68:71], v[76:79], v[88:91]
    ds_read_b64 v[46:47], v96 offset:2120
    s_waitcnt lgkmcnt(12)
    v_mfma_f32_16x16x32_bf16 v[92:95], v[72:75], v[76:79], v[92:95]
    ds_read_b128 v[48:51], v97 offset:1536
    ds_read_b64 v[52:53], v96 offset:3584
    s_waitcnt lgkmcnt(10)
    v_mfma_f32_16x16x32_bf16 v[92:95], v[20:23], v[16:19], v[92:95]
    ds_read_b64 v[54:55], v96 offset:3592
    ds_read_b128 v[60:63], v97 offset:1024
    v_mfma_f32_16x16x32_bf16 v[88:91], v[20:23], v[28:31], v[88:91]
    ds_read_b64 v[56:57], v96 offset:3072
    ds_read_b64 v[58:59], v96 offset:3080
    s_waitcnt lgkmcnt(11)
    v_mfma_f32_16x16x32_bf16 v[92:95], v[24:27], v[28:31], v[92:95]
    ds_read_b128 v[64:67], v97 offset:512
    ds_read_b64 v[68:69], v96 offset:2560
    v_mfma_f32_16x16x32_bf16 v[88:91], v[24:27], v[32:35], v[88:91]
    ds_read_b64 v[70:71], v96 offset:2568
    s_waitcnt lgkmcnt(11)
    v_mfma_f32_16x16x32_bf16 v[92:95], v[36:39], v[32:35], v[92:95]
    ds_read_b128 v[72:75], v97 offset:0
    ds_read_b64 v[76:77], v96 offset:2048
    v_mfma_f32_16x16x32_bf16 v[88:91], v[36:39], v[40:43], v[88:91]
    ds_read_b64 v[78:79], v96 offset:2056
    s_waitcnt lgkmcnt(12)
    v_mfma_f32_16x16x32_bf16 v[92:95], v[44:47], v[40:43], v[92:95]
    ds_read_b128 v[16:19], v97 offset:2752
    ds_read_b64 v[20:21], v96 offset:3776
    s_waitcnt lgkmcnt(10)
    v_mfma_f32_16x16x32_bf16 v[92:95], v[52:55], v[48:51], v[92:95]
    ds_read_b64 v[22:23], v96 offset:3784
    ds_read_b128 v[28:31], v97 offset:2240
    v_mfma_f32_16x16x32_bf16 v[88:91], v[52:55], v[60:63], v[88:91]
    ds_read_b64 v[24:25], v96 offset:3264
    ds_read_b64 v[26:27], v96 offset:3272
    s_waitcnt lgkmcnt(11)
    v_mfma_f32_16x16x32_bf16 v[92:95], v[56:59], v[60:63], v[92:95]
    ds_read_b128 v[32:35], v97 offset:1728
    ds_read_b64 v[36:37], v96 offset:2752
    v_mfma_f32_16x16x32_bf16 v[88:91], v[56:59], v[64:67], v[88:91]
    ds_read_b64 v[38:39], v96 offset:2760
    s_waitcnt lgkmcnt(11)
    v_mfma_f32_16x16x32_bf16 v[92:95], v[68:71], v[64:67], v[92:95]
    ds_read_b128 v[44:47], v97 offset:1216
    ds_read_b64 v[40:41], v96 offset:2240
    v_mfma_f32_16x16x32_bf16 v[88:91], v[68:71], v[72:75], v[88:91]
    ds_read_b64 v[42:43], v96 offset:2248
    s_waitcnt lgkmcnt(12)
    v_mfma_f32_16x16x32_bf16 v[92:95], v[76:79], v[72:75], v[92:95]
    ds_read_b128 v[48:51], v97 offset:704
    ds_read_b64 v[52:53], v96 offset:1728
    s_nop 2
    ds_write_b128 v98, v[88:91] offset:8192
    s_waitcnt lgkmcnt(14)
    s_nop 0
    ds_write_b128 v98, v[92:95] offset:9216
    s_waitcnt lgkmcnt(0)
    s_barrier
    v_mfma_f32_16x16x32_bf16 v[84:87], v[20:23], v[16:19], 0
    ds_read_b64 v[54:55], v96 offset:1736
    ds_read_b128 v[60:63], v97 offset:192
    v_mfma_f32_16x16x32_bf16 v[80:83], v[20:23], v[28:31], 0
    ds_read_b64 v[56:57], v96 offset:1216
    ds_read_b64 v[58:59], v96 offset:1224
    v_mfma_f32_16x16x32_bf16 v[84:87], v[24:27], v[28:31], v[84:87]
    ds_read_b128 v[64:67], v97 offset:2688
    ds_read_b64 v[68:69], v96 offset:3712
    v_mfma_f32_16x16x32_bf16 v[80:83], v[24:27], v[32:35], v[80:83]
    ds_read_b64 v[70:71], v96 offset:3720
    ds_read_b128 v[76:79], v97 offset:2176
    v_mfma_f32_16x16x32_bf16 v[84:87], v[36:39], v[32:35], v[84:87]
    ds_read_b64 v[72:73], v96 offset:3200
    ds_read_b64 v[74:75], v96 offset:3208
    v_mfma_f32_16x16x32_bf16 v[80:83], v[36:39], v[44:47], v[80:83]
    ds_read_b128 v[16:19], v97 offset:1664
    ds_read_b64 v[20:21], v96 offset:2688
    v_mfma_f32_16x16x32_bf16 v[84:87], v[40:43], v[44:47], v[84:87]
    ds_read_b64 v[22:23], v96 offset:2696
    ds_read_b128 v[28:31], v97 offset:1152
    v_mfma_f32_16x16x32_bf16 v[80:83], v[40:43], v[48:51], v[80:83]
    s_waitcnt lgkmcnt(12)
    v_mfma_f32_16x16x32_bf16 v[84:87], v[52:55], v[48:51], v[84:87]
    ds_read_b64 v[24:25], v96 offset:2176
    ds_read_b64 v[26:27], v96 offset:2184
    v_mfma_f32_16x16x32_bf16 v[80:83], v[52:55], v[60:63], v[80:83]
    s_waitcnt lgkmcnt(12)
    v_mfma_f32_16x16x32_bf16 v[84:87], v[56:59], v[60:63], v[84:87]
    ds_read_b128 v[32:35], v97 offset:640
    ds_read_b64 v[36:37], v96 offset:1664
    s_waitcnt lgkmcnt(10)
    v_mfma_f32_16x16x32_bf16 v[84:87], v[68:71], v[64:67], v[84:87]
    ds_read_b64 v[38:39], v96 offset:1672
    ds_read_b128 v[44:47], v97 offset:128
    v_mfma_f32_16x16x32_bf16 v[80:83], v[68:71], v[76:79], v[80:83]
    ds_read_b64 v[40:41], v96 offset:1152
    ds_read_b64 v[42:43], v96 offset:1160
    s_waitcnt lgkmcnt(11)
    v_mfma_f32_16x16x32_bf16 v[84:87], v[72:75], v[76:79], v[84:87]
    ds_read_b128 v[48:51], v97 offset:2624
    ds_read_b64 v[52:53], v96 offset:3648
    v_mfma_f32_16x16x32_bf16 v[80:83], v[72:75], v[16:19], v[80:83]
    ds_read_b64 v[54:55], v96 offset:3656
    s_waitcnt lgkmcnt(11)
    v_mfma_f32_16x16x32_bf16 v[84:87], v[20:23], v[16:19], v[84:87]
    ds_read_b128 v[56:59], v97 offset:2112
    ds_read_b64 v[60:61], v96 offset:3136
    v_mfma_f32_16x16x32_bf16 v[80:83], v[20:23], v[28:31], v[80:83]
    ds_read_b64 v[62:63], v96 offset:3144
    s_waitcnt lgkmcnt(11)
    v_mfma_f32_16x16x32_bf16 v[84:87], v[24:27], v[28:31], v[84:87]
    ds_read_b128 v[64:67], v97 offset:1600
    ds_read_b64 v[68:69], v96 offset:2624
    v_mfma_f32_16x16x32_bf16 v[80:83], v[24:27], v[32:35], v[80:83]
    ds_read_b64 v[70:71], v96 offset:2632
    s_waitcnt lgkmcnt(11)
    v_mfma_f32_16x16x32_bf16 v[84:87], v[36:39], v[32:35], v[84:87]
    ds_read_b128 v[76:79], v97 offset:1088
    ds_read_b64 v[72:73], v96 offset:2112
    v_mfma_f32_16x16x32_bf16 v[80:83], v[36:39], v[44:47], v[80:83]
    ds_read_b64 v[74:75], v96 offset:2120
    s_waitcnt lgkmcnt(12)
    v_mfma_f32_16x16x32_bf16 v[84:87], v[40:43], v[44:47], v[84:87]
    ds_read_b128 v[16:19], v97 offset:576
    ds_read_b64 v[20:21], v96 offset:1600
    s_waitcnt lgkmcnt(10)
    v_mfma_f32_16x16x32_bf16 v[84:87], v[52:55], v[48:51], v[84:87]
    ds_read_b64 v[22:23], v96 offset:1608
    ds_read_b128 v[28:31], v97 offset:64
    v_mfma_f32_16x16x32_bf16 v[80:83], v[52:55], v[56:59], v[80:83]
    ds_read_b64 v[24:25], v96 offset:1088
    ds_read_b64 v[26:27], v96 offset:1096
    s_waitcnt lgkmcnt(11)
    v_mfma_f32_16x16x32_bf16 v[84:87], v[60:63], v[56:59], v[84:87]
    ds_read_b128 v[32:35], v97 offset:2560
    ds_read_b64 v[36:37], v96 offset:3584
    v_mfma_f32_16x16x32_bf16 v[80:83], v[60:63], v[64:67], v[80:83]
    ds_read_b64 v[38:39], v96 offset:3592
    s_waitcnt lgkmcnt(11)
    v_mfma_f32_16x16x32_bf16 v[84:87], v[68:71], v[64:67], v[84:87]
    ds_read_b128 v[40:43], v97 offset:2048
    ds_read_b64 v[44:45], v96 offset:3072
    v_mfma_f32_16x16x32_bf16 v[80:83], v[68:71], v[76:79], v[80:83]
    ds_read_b64 v[46:47], v96 offset:3080
    s_waitcnt lgkmcnt(11)
    v_mfma_f32_16x16x32_bf16 v[84:87], v[72:75], v[76:79], v[84:87]
    ds_read_b128 v[48:51], v97 offset:1536
    ds_read_b64 v[52:53], v96 offset:2560
    v_mfma_f32_16x16x32_bf16 v[80:83], v[72:75], v[16:19], v[80:83]
    ds_read_b64 v[54:55], v96 offset:2568
    s_waitcnt lgkmcnt(11)
    v_mfma_f32_16x16x32_bf16 v[84:87], v[20:23], v[16:19], v[84:87]
    ds_read_b128 v[56:59], v97 offset:1024
    ds_read_b64 v[60:61], v96 offset:2048
    v_mfma_f32_16x16x32_bf16 v[80:83], v[20:23], v[28:31], v[80:83]
    ds_read_b64 v[62:63], v96 offset:2056
    s_waitcnt lgkmcnt(12)
    v_mfma_f32_16x16x32_bf16 v[84:87], v[24:27], v[28:31], v[84:87]
    ds_read_b128 v[64:67], v97 offset:512
    ds_read_b64 v[68:69], v96 offset:1536
    s_waitcnt lgkmcnt(10)
    v_mfma_f32_16x16x32_bf16 v[84:87], v[36:39], v[32:35], v[84:87]
    ds_read_b64 v[70:71], v96 offset:1544
    ds_read_b128 v[76:79], v97 offset:0
    v_mfma_f32_16x16x32_bf16 v[80:83], v[36:39], v[40:43], v[80:83]
    ds_read_b64 v[72:73], v96 offset:1024
    ds_read_b64 v[74:75], v96 offset:1032
    s_waitcnt lgkmcnt(11)
    v_mfma_f32_16x16x32_bf16 v[84:87], v[44:47], v[40:43], v[84:87]
    ds_read_b128 v[16:19], v97 offset:3776
    ds_read_b64 v[20:21], v96 offset:3776
    v_mfma_f32_16x16x32_bf16 v[80:83], v[44:47], v[48:51], v[80:83]
    ds_read_b64 v[22:23], v96 offset:3784
    s_waitcnt lgkmcnt(11)
    v_mfma_f32_16x16x32_bf16 v[84:87], v[52:55], v[48:51], v[84:87]
    ds_read_b128 v[24:27], v97 offset:3264
    ds_read_b64 v[28:29], v96 offset:3264
    v_mfma_f32_16x16x32_bf16 v[80:83], v[52:55], v[56:59], v[80:83]
    ds_read_b64 v[30:31], v96 offset:3272
    s_waitcnt lgkmcnt(11)
    v_mfma_f32_16x16x32_bf16 v[84:87], v[60:63], v[56:59], v[84:87]
    ds_read_b128 v[32:35], v97 offset:2752
    ds_read_b64 v[36:37], v96 offset:2752
    v_mfma_f32_16x16x32_bf16 v[80:83], v[60:63], v[64:67], v[80:83]
    ds_read_b64 v[38:39], v96 offset:2760
    s_waitcnt lgkmcnt(11)
    v_mfma_f32_16x16x32_bf16 v[84:87], v[68:71], v[64:67], v[84:87]
    ds_read_b128 v[40:43], v97 offset:2240
    ds_read_b64 v[44:45], v96 offset:2240
    v_mfma_f32_16x16x32_bf16 v[80:83], v[68:71], v[76:79], v[80:83]
    ds_read_b64 v[46:47], v96 offset:2248
    s_waitcnt lgkmcnt(12)
    v_mfma_f32_16x16x32_bf16 v[84:87], v[72:75], v[76:79], v[84:87]
    ds_read_b128 v[48:51], v97 offset:1728
    ds_read_b64 v[52:53], v96 offset:1728
    s_nop 2
    ds_write_b128 v98, v[80:83] offset:16384
    s_waitcnt lgkmcnt(14)
    s_nop 0
    ds_write_b128 v98, v[84:87] offset:17408
    s_waitcnt lgkmcnt(0)
    s_barrier
    v_mfma_f32_16x16x32_bf16 v[92:95], v[20:23], v[16:19], 0
    ds_read_b64 v[54:55], v96 offset:1736
    ds_read_b128 v[56:59], v97 offset:1216
    s_cmp_eq_u32 s34, 0
    s_cbranch_scc0 L_nomp_18
    buffer_load_dwordx4 v[100:103], v99, s[40:43], s60 offen sc1
L_nomp_18:
    v_mfma_f32_16x16x32_bf16 v[88:91], v[20:23], v[24:27], 0
    ds_read_b64 v[60:61], v96 offset:1216
    ds_read_b64 v[62:63], v96 offset:1224
    v_mfma_f32_16x16x32_bf16 v[92:95], v[28:31], v[24:27], v[92:95]
    ds_read_b128 v[64:67], v97 offset:704
    ds_read_b64 v[68:69], v96 offset:704
    v_mfma_f32_16x16x32_bf16 v[88:91], v[28:31], v[32:35], v[88:91]
    ds_read_b64 v[70:71], v96 offset:712
    ds_read_b128 v[72:75], v97 offset:192
    v_mfma_f32_16x16x32_bf16 v[92:95], v[36:39], v[32:35], v[92:95]
    ds_read_b64 v[76:77], v96 offset:192
    ds_read_b64 v[78:79], v96 offset:200
    v_mfma_f32_16x16x32_bf16 v[88:91], v[36:39], v[40:43], v[88:91]
    ds_read_b128 v[16:19], v97 offset:3712
    ds_read_b64 v[20:21], v96 offset:3712
    v_mfma_f32_16x16x32_bf16 v[92:95], v[44:47], v[40:43], v[92:95]
    ds_read_b64 v[22:23], v96 offset:3720
    ds_read_b128 v[24:27], v97 offset:3200
    v_mfma_f32_16x16x32_bf16 v[88:91], v[44:47], v[48:51], v[88:91]
    s_waitcnt lgkmcnt(12)
    v_mfma_f32_16x16x32_bf16 v[92:95], v[52:55], v[48:51], v[92:95]
    ds_read_b64 v[28:29], v96 offset:3200
    ds_read_b64 v[30:31], v96 offset:3208
    v_mfma_f32_16x16x32_bf16 v[88:91], v[52:55], v[56:59], v[88:91]
    s_waitcnt lgkmcnt(11)
    v_mfma_f32_16x16x32_bf16 v[92:95], v[60:63], v[56:59], v[92:95]
    ds_read_b128 v[32:35], v97 offset:2688
    ds_read_b64 v[36:37], v96 offset:2688
    v_mfma_f32_16x16x32_bf16 v[88:91], v[60:63], v[64:67], v[88:91]
    ds_read_b64 v[38:39], v96 offset:2696
    s_waitcnt lgkmcnt(11)
    v_mfma_f32_16x16x32_bf16 v[92:95], v[68:71], v[64:67], v[92:95]
    ds_read_b128 v[40:43], v97 offset:2176
    ds_read_b64 v[44:45], v96 offset:2176
    v_mfma_f32_16x16x32_bf16 v[88:91], v[68:71], v[72:75], v[88:91]
    ds_read_b64 v[46:47], v96 offset:2184
    s_waitcnt lgkmcnt(12)
    v_mfma_f32_16x16x32_bf16 v[92:95], v[76:79], v[72:75], v[92:95]
    ds_read_b128 v[48:51], v97 offset:1664
    ds_read_b64 v[52:53], v96 offset:1664
    s_waitcnt lgkmcnt(10)
    v_mfma_f32_16x16x32_bf16 v[92:95], v[20:23], v[16:19], v[92:95]
    ds_read_b64 v[54:55], v96 offset:1672
    ds_read_b128 v[56:59], v97 offset:1152
    v_mfma_f32_16x16x32_bf16 v[88:91], v[20:23], v[24:27], v[88:91]
    ds_read_b64 v[60:61], v96 offset:1152
    ds_read_b64 v[62:63], v96 offset:1160
    s_waitcnt lgkmcnt(11)
    v_mfma_f32_16x16x32_bf16 v[92:95], v[28:31], v[24:27], v[92:95]
    ds_read_b128 v[64:67], v97 offset:640
    ds_read_b64 v[68:69], v96 offset:640
    v_mfma_f32_16x16x32_bf16 v[88:91], v[28:31], v[32:35], v[88:91]
    ds_read_b64 v[70:71], v96 offset:648
    s_waitcnt lgkmcnt(11)
    v_mfma_f32_16x16x32_bf16 v[92:95], v[36:39], v[32:35], v[92:95]
    ds_read_b128 v[76:79], v97 offset:128
    ds_read_b64 v[72:73], v96 offset:128
    v_mfma_f32_16x16x32_bf16 v[88:91], v[36:39], v[40:43], v[88:91]
    ds_read_b64 v[74:75], v96 offset:136
    s_waitcnt lgkmcnt(11)
    v_mfma_f32_16x16x32_bf16 v[92:95], v[44:47], v[40:43], v[92:95]
    ds_read_b128 v[16:19], v97 offset:3648
    ds_read_b64 v[20:21], v96 offset:3648
    v_mfma_f32_16x16x32_bf16 v[88:91], v[44:47], v[48:51], v[88:91]
    ds_read_b64 v[22:23], v96 offset:3656
    s_waitcnt lgkmcnt(11)
    v_mfma_f32_16x16x32_bf16 v[92:95], v[52:55], v[48:51], v[92:95]
    ds_read_b128 v[24:27], v97 offset:3136
    ds_read_b64 v[28:29], v96 offset:3136
    v_mfma_f32_16x16x32_bf16 v[88:91], v[52:55], v[56:59], v[88:91]
    ds_read_b64 v[30:31], v96 offset:3144
    s_waitcnt lgkmcnt(11)
    v_mfma_f32_16x16x32_bf16 v[92:95], v[60:63], v[56:59], v[92:95]
    ds_read_b128 v[32:35], v97 offset:2624
    ds_read_b64 v[36:37], v96 offset:2624
    v_mfma_f32_16x16x32_bf16 v[88:91], v[60:63], v[64:67], v[88:91]
    ds_read_b64 v[38:39], v96 offset:2632
    s_waitcnt lgkmcnt(11)
    v_mfma_f32_16x16x32_bf16 v[92:95], v[68:71], v[64:67], v[92:95]
    ds_read_b128 v[40:43], v97 offset:2112
    ds_read_b64 v[44:45], v96 offset:2112
    v_mfma_f32_16x16x32_bf16 v[88:91], v[68:71], v[76:79], v[88:91]
    ds_read_b64 v[46:47], v96 offset:2120
    s_waitcnt lgkmcnt(12)
    v_mfma_f32_16x16x32_bf16 v[92:95], v[72:75], v[76:79], v[92:95]
    ds_read_b128 v[48:51], v97 offset:1600
    ds_read_b64 v[52:53], v96 offset:1600
    s_waitcnt lgkmcnt(10)
    v_mfma_f32_16x16x32_bf16 v[92:95], v[20:23], v[16:19], v[92:95]
    ds_read_b64 v[54:55], v96 offset:1608
    ds_read_b128 v[56:59], v97 offset:1088
    v_mfma_f32_16x16x32_bf16 v[88:91], v[20:23], v[24:27], v[88:91]
    ds_read_b64 v[60:61], v96 offset:1088
    ds_read_b64 v[62:63], v96 offset:1096
    s_waitcnt lgkmcnt(11)
    v_mfma_f32_16x16x32_bf16 v[92:95], v[28:31], v[24:27], v[92:95]
    ds_read_b128 v[64:67], v97 offset:576
    ds_read_b64 v[68:69], v96 offset:576
    v_mfma_f32_16x16x32_bf16 v[88:91], v[28:31], v[32:35], v[88:91]
    ds_read_b64 v[70:71], v96 offset:584
    s_waitcnt lgkmcnt(11)
    v_mfma_f32_16x16x32_bf16 v[92:95], v[36:39], v[32:35], v[92:95]
    ds_read_b128 v[72:75], v97 offset:64
    ds_read_b64 v[76:77], v96 offset:64
    v_mfma_f32_16x16x32_bf16 v[88:91], v[36:39], v[40:43], v[88:91]
    ds_read_b64 v[78:79], v96 offset:72
    s_waitcnt lgkmcnt(11)
    v_mfma_f32_16x16x32_bf16 v[92:95], v[44:47], v[40:43], v[92:95]
    ds_read_b128 v[16:19], v97 offset:3584
    ds_read_b64 v[20:21], v96 offset:3584
    v_mfma_f32_16x16x32_bf16 v[88:91], v[44:47], v[48:51], v[88:91]
    ds_read_b64 v[22:23], v96 offset:3592
    s_waitcnt lgkmcnt(11)
    v_mfma_f32_16x16x32_bf16 v[92:95], v[52:55], v[48:51], v[92:95]
    ds_read_b128 v[24:27], v97 offset:3072
    ds_read_b64 v[28:29], v96 offset:3072
    v_mfma_f32_16x16x32_bf16 v[88:91], v[52:55], v[56:59], v[88:91]
    ds_read_b64 v[30:31], v96 offset:3080
    s_waitcnt lgkmcnt(11)
    v_mfma_f32_16x16x32_bf16 v[92:95], v[60:63], v[56:59], v[92:95]
    ds_read_b128 v[32:35], v97 offset:2560
    ds_read_b64 v[36:37], v96 offset:2560
    v_mfma_f32_16x16x32_bf16 v[88:91], v[60:63], v[64:67], v[88:91]
    ds_read_b64 v[38:39], v96 offset:2568
    s_waitcnt lgkmcnt(11)
    v_mfma_f32_16x16x32_bf16 v[92:95], v[68:71], v[64:67], v[92:95]
    ds_read_b128 v[40:43], v97 offset:2048
    ds_read_b64 v[44:45], v96 offset:2048
    v_mfma_f32_16x16x32_bf16 v[88:91], v[68:71], v[72:75], v[88:91]
    ds_read_b64 v[46:47], v96 offset:2056
    s_waitcnt lgkmcnt(12)
    v_mfma_f32_16x16x32_bf16 v[92:95], v[76:79], v[72:75], v[92:95]
    ds_read_b128 v[48:51], v97 offset:1536
    ds_read_b64 v[52:53], v96 offset:1536
    s_waitcnt lgkmcnt(10)
    v_mfma_f32_16x16x32_bf16 v[92:95], v[20:23], v[16:19], v[92:95]
    ds_read_b64 v[54:55], v96 offset:1544
    ds_read_b128 v[56:59], v97 offset:1024
    v_mfma_f32_16x16x32_bf16 v[88:91], v[20:23], v[24:27], v[88:91]
    ds_read_b64 v[60:61], v96 offset:1024
    ds_read_b64 v[62:63], v96 offset:1032
    s_waitcnt lgkmcnt(11)
    v_mfma_f32_16x16x32_bf16 v[92:95], v[28:31], v[24:27], v[92:95]
    ds_read_b128 v[64:67], v97 offset:512
    ds_read_b64 v[68:69], v96 offset:512
    v_mfma_f32_16x16x32_bf16 v[88:91], v[28:31], v[32:35], v[88:91]
    ds_read_b64 v[70:71], v96 offset:520
    s_waitcnt lgkmcnt(11)
    v_mfma_f32_16x16x32_bf16 v[92:95], v[36:39], v[32:35], v[92:95]
    ds_read_b128 v[76:79], v97 offset:0
    ds_read_b64 v[72:73], v96 offset:0
    v_mfma_f32_16x16x32_bf16 v[88:91], v[36:39], v[40:43], v[88:91]
    ds_read_b64 v[74:75], v96 offset:8
    s_waitcnt lgkmcnt(11)
    v_mfma_f32_16x16x32_bf16 v[92:95], v[44:47], v[40:43], v[92:95]
    v_mfma_f32_16x16x32_bf16 v[88:91], v[44:47], v[48:51], v[88:91]
    s_waitcnt lgkmcnt(8)
    v_mfma_f32_16x16x32_bf16 v[92:95], v[52:55], v[48:51], v[92:95]
    v_mfma_f32_16x16x32_bf16 v[88:91], v[52:55], v[56:59], v[88:91]
    s_waitcnt lgkmcnt(5)
    v_mfma_f32_16x16x32_bf16 v[92:95], v[60:63], v[56:59], v[92:95]
    v_mfma_f32_16x16x32_bf16 v[88:91], v[60:63], v[64:67], v[88:91]
    s_waitcnt lgkmcnt(2)
    v_mfma_f32_16x16x32_bf16 v[92:95], v[68:71], v[64:67], v[92:95]
    v_mfma_f32_16x16x32_bf16 v[88:91], v[68:71], v[76:79], v[88:91]
    s_waitcnt lgkmcnt(0)
    v_mfma_f32_16x16x32_bf16 v[92:95], v[72:75], v[76:79], v[92:95]
    s_nop 5
    ds_write_b128 v98, v[88:91] offset:24576
    s_nop 0
    ds_write_b128 v98, v[92:95] offset:25600
    s_waitcnt lgkmcnt(0)
    s_barrier
    s_cmp_eq_u32 s34, 0
    s_cbranch_scc0 L_nofix_19
    s_mov_b32 s62, 0
    s_waitcnt vmcnt(0)
L_mp_20:
    v_cmp_ne_u32 vcc, s36, v103
    s_cbranch_vccz L_mpok_21
    s_add_u32 s62, s62, 1
    s_cmp_ge_u32 s62, 4000
    s_cbranch_scc1 L_mpok_21
    buffer_load_dwordx4 v[100:103], v99, s[40:43], s60 offen sc1
    s_waitcnt vmcnt(0)
    s_branch L_mp_20
L_mpok_21:
    v_readlane_b32 s60, v102, 0
    v_readlane_b32 s61, v102, 1
    v_add_f32_dpp v100, v100, v100 row_ror:2 row_mask:0xf bank_mask:0xf
    v_add_f32_dpp v101, v101, v101 row_ror:2 row_mask:0xf bank_mask:0xf
    s_nop 0
    v_add_f32_dpp v100, v100, v100 row_ror:4 row_mask:0xf bank_mask:0xf
    v_add_f32_dpp v101, v101, v101 row_ror:4 row_mask:0xf bank_mask:0xf
    s_nop 0
    v_add_f32_dpp v100, v100, v100 row_ror:8 row_mask:0xf bank_mask:0xf
    v_add_f32_dpp v101, v101, v101 row_ror:8 row_mask:0xf bank_mask:0xf
    v_mov_b32 v12, v100
    v_mov_b32 v13, v101
    s_nop 0
    v_permlane16_swap_b32 v100, v12
    v_permlane16_swap_b32 v101, v13
    v_add_f32 v100, v100, v12
    v_add_f32 v101, v101, v13
    v_mov_b32 v12, v100
    v_mov_b32 v13, v101
    s_nop 0
    v_permlane32_swap_b32 v100, v12
    v_permlane32_swap_b32 v101, v13
    v_add_f32 v100, v100, v12
    v_add_f32 v101, v101, v13
    v_and_b32 v16, 1, v1
    v_bfe_u32 v17, v1, 1, 1
    v_cmp_eq_u32 vcc, 1, v17
    v_mov_b32 v18, s60
    v_mov_b32 v19, s61
    v_cndmask_b32 v18, v18, v19, vcc
    v_cndmask_b32 v100, v100, v101, vcc
    v_and_b32 v19, 0x7ff, v18
    v_sub_u32 v19, 2047, v19
    v_lshrrev_b32 v20, 16, v18
    v_bfe_i32 v21, v18, 31, 1
    v_not_b32 v21, v21
    v_and_b32 v21, 0x7fff, v21
    v_or_b32 v21, 0x8000, v21
    v_xor_b32 v20, v20, v21
    v_lshlrev_b32 v20, 16, v20
    v_mul_f32 v20, 0xbfb8aa3b, v20
    v_lshlrev_b32 v22, 1, v19
    v_mul_u32_u24 v23, 4672, v16
    v_add_u32 v23, v23, v22
    v_exp_f32 v20, v20
    ds_read_u16 v28, v23 offset:512
    v_add_f32 v20, 1.0, v20
    v_rcp_f32 v20, v20
    v_cvt_pk_bf16_f32 v100, 0, v100
    v_cvt_pk_bf16_f32 v20, 0, v20
    v_mul_f32 v21, v100, v20
    v_cvt_pk_bf16_f32 v21, 0, v21
    s_waitcnt lgkmcnt(0)
    v_lshlrev_b32 v28, 16, v28
    v_add_f32 v28, v28, v21
    v_cvt_pk_bf16_f32 v28, 0, v28
    v_mul_f32 v31, 0xbfb8aa3b, v28
    v_exp_f32 v31, v31
    s_nop 0
    v_add_f32 v31, 1.0, v31
    v_rcp_f32 v31, v31
    s_nop 0
    v_mul_f32 v27, v28, v31
    v_cvt_pk_bf16_f32 v27, 0, v27
    s_nop 1
    v_mov_b32_dpp v26, v27 quad_perm:[1,0,3,2] row_mask:0xf bank_mask:0xf
    v_cvt_pk_bf16_f32 v26, v27, v26
    v_readlane_b32 s52, v19, 0
    v_readlane_b32 s53, v19, 2
    v_readlane_b32 s54, v26, 0
    v_readlane_b32 s55, v26, 2
    v_mov_b32 v32, s52
    v_mov_b32 v33, s53
    v_mov_b32 v34, s54
    v_mov_b32 v35, s55
    v_mov_b32 v31, 149584
    s_mov_b64 exec, 1
    ds_write_b128 v31, v[32:35]
    s_mov_b64 exec, -1
    s_waitcnt lgkmcnt(0)
    s_barrier
L_nofix_19:
    s_branch L_end
L_V:
    s_waitcnt lgkmcnt(0)
    s_load_dword s36, s[32:33], 0
    global_load_ushort v4, v2, s[6:7]
    global_load_ushort v5, v2, s[8:9]
    s_lshl_b32 s53, s35, 2
    s_load_dword s38, s[14:15], s53
    s_load_dword s39, s[16:17], s53
    s_mov_b32 s40, s32
    s_and_b32 s41, s33, 0xffff
    s_mov_b32 s42, 0x00221000
    s_mov_b32 s43, 0x00020000
    s_mov_b32 s44, s28
    s_and_b32 s45, s29, 0xffff
    s_mov_b32 s46, 0x001c0000
    s_mov_b32 s47, 0x00020000
    s_sub_u32 s67, s34, 8
    s_mul_i32 s56, s67, 7
    v_lshrrev_b32 v20, 4, v1
    v_add_u32 v20, s56, v20
    v_cmp_le_u32 vcc, 28, v20
    v_subrev_u32 v21, 28, v20
    s_nop 0
    v_cndmask_b32 v21, v20, v21, vcc
    v_mov_b32 v22, 0
    v_mov_b32 v23, 1088
    v_cndmask_b32 v22, v22, v23, vcc
    v_lshl_add_u32 v22, v21, 3, v22
    v_and_b32 v23, 3, v1
    v_mul_u32_u24 v23, 272, v23
    v_add_u32 v22, v22, v23
    v_bfe_u32 v23, v1, 2, 2
    v_mul_u32_u24 v23, 2368, v23
    v_add_u32 v22, v22, v23
    v_add_u32 v120, 110336, v22
    v_add_u32 v20, 4, v20
    v_cmp_le_u32 vcc, 28, v20
    v_subrev_u32 v21, 28, v20
    s_nop 0
    v_cndmask_b32 v21, v20, v21, vcc
    v_mov_b32 v22, 0
    v_mov_b32 v23, 1088
    v_cndmask_b32 v22, v22, v23, vcc
    v_lshl_add_u32 v22, v21, 3, v22
    v_and_b32 v23, 3, v1
    v_mul_u32_u24 v23, 272, v23
    v_add_u32 v22, v22, v23
    v_bfe_u32 v23, v1, 2, 2
    v_mul_u32_u24 v23, 2368, v23
    v_add_u32 v22, v22, v23
    v_add_u32 v116, 110336, v22
    v_lshlrev_b32 v22, 4, v1
    s_mul_i32 s56, s67, 1792
    v_add_u32 v121, s56, v22
    v_and_b32 v24, 3, v1
    v_lshrrev_b32 v25, 2, v1
    v_lshl_add_u32 v25, v24, 4, v25
    v_cmp_gt_u32 s[64:65], 28, v25
    s_mul_i32 s56, s67, 112
    v_lshl_add_u32 v122, v25, 2, s56
    v_and_b32 v20, 511, v0
    v_lshrrev_b32 v21, 2, v20
    v_mul_u32_u24 v22, 14336, v21
    v_and_b32 v23, 3, v20
    v_lshl_add_u32 v123, v23, 4, v22
    v_mul_u32_u24 v124, 896, v21
    v_lshlrev_b32 v117, 7, v21
    v_lshl_add_u32 v117, v23, 5, v117
    v_lshrrev_b32 v24, 1, v20
    v_and_b32 v23, 1, v20
    v_lshlrev_b32 v25, 4, v24
    v_mul_u32_u24 v26, 4672, v23
    v_add_u32 v26, v26, v25
    v_add_u32 v118, 512, v26
    v_mul_u32_u24 v26, 4160, v23
    v_add_u32 v26, v26, v25
    v_add_u32 v125, 9344, v26
    v_lshlrev_b32 v100, 7, v1
    v_bfe_u32 v20, v1, 3, 2
    v_and_b32 v21, 7, v1
    v_lshlrev_b32 v22, 1, v21
    v_sub_u32 v22, v20, v22
    v_lshrrev_b32 v23, 5, v1
    v_mul_u32_u24 v24, 2880, v23
    v_add_u32 v24, 143616, v24
    v_cvt_f32_i32 v25, v22
    v_lshrrev_b32 v25, 16, v25
    s_movk_i32 s58, 0x3f7f
    v_sub_u32 v25, v25, s58 clamp
    v_cmp_gt_i32 vcc, 0, v22
    v_mov_b32 v26, 1424
    s_nop 0
    v_cndmask_b32 v25, v25, v26, vcc
    v_lshl_add_u32 v113, v25, 1, v24
    v_add_u32 v22, -1, v22
    v_cvt_f32_i32 v25, v22
    v_lshrrev_b32 v25, 16, v25
    s_movk_i32 s58, 0x3f7f
    v_sub_u32 v25, v25, s58 clamp
    v_cmp_gt_i32 vcc, 0, v22
    v_mov_b32 v26, 1424
    s_nop 0
    v_cndmask_b32 v25, v25, v26, vcc
    v_lshl_add_u32 v114, v25, 1, v24
    v_mul_u32_u24 v23, 16640, v23
    v_mul_u32_u24 v20, 4160, v20
    v_add_u32 v23, v23, v20
    v_lshl_add_u32 v23, v21, 2, v23
    v_add_u32 v115, 114432, v23
    s_sub_u32 s52, s34, 4
    s_lshr_b32 s57, s52, 2
    s_bfe_u32 s53, s52, 0x10001
    s_and_b32 s54, s52, 1
    v_and_b32 v26, 15, v1
    v_lshrrev_b32 v27, 4, v1
    v_lshlrev_b32 v26, 4, v26
    v_lshl_add_u32 v26, v27, 2, v26
    s_lshl_b32 s55, s53, 8
    s_lshl_b32 s56, s54, 1
    s_add_u32 s55, s55, s56
    s_lshl_b32 s56, s57, 9
    s_add_u32 s55, s55, s56
    v_add_u32 v26, s55, v26
    v_lshlrev_b32 v96, 1, v26
    v_mul_u32_u24 v97, 896, v26
    s_lshl_b32 s55, s53, 10
    s_lshl_b32 s56, s54, 3
    s_add_u32 s55, s55, s56
    s_lshl_b32 s56, s57, 13
    s_add_u32 s55, s55, s56
    s_add_u32 s55, s55, 25856
    v_lshl_add_u32 v98, v1, 4, s55
    s_and_b32 s55, s52, 3
    s_lshl_b32 s55, s55, 9
    s_lshl_b32 s56, s57, 11
    s_add_u32 s55, s55, s56
    s_add_u32 s55, s55, 17664
    v_lshl_add_u32 v99, v1, 3, s55
    s_waitcnt lgkmcnt(0)
    s_bfe_u32 s52, s34, 0x10002
    s_lshl_b32 s53, s38, 16
    s_and_b32 s54, s38, 0xffff0000
    s_cmp_eq_u32 s52, 0
    s_cselect_b32 s53, s53, s54
    v_mov_b32 v40, s53
    v_mul_f32 v42, 0x3fb8aa00, v40
    v_rndne_f32 v43, v42
    v_sub_f32 v42, v42, v43
    v_fmac_f32 v42, 0x36eca570, v40
    v_cvt_i32_f32 v43, v43
    v_exp_f32 v42, v42
    s_nop 0
    v_ldexp_f32 v41, v42, v43
    v_cvt_pk_bf16_f32 v126, 0, v41
    s_add_u32 s36, s36, 1
    s_waitcnt vmcnt(0)
    v_lshlrev_b32 v4, 16, v4
    v_lshlrev_b32 v5, 16, v5
    v_mul_f32 v13, 0x3fb8aa00, v4
    v_rndne_f32 v14, v13
    v_sub_f32 v13, v13, v14
    v_fmac_f32 v13, 0x36eca570, v4
    v_cvt_i32_f32 v14, v14
    v_exp_f32 v13, v13
    s_nop 0
    v_ldexp_f32 v12, v13, v14
    v_mul_f32 v13, v126, v5
    v_mov_b32 v10, v126
    v_cvt_pk_bf16_f32 v11, 0, v12
    v_mul_f32 v13, 0x3e22f983, v13
    v_mul_f32 v12, v10, v11
    v_mul_f32 v12, 0xbfb8aa3b, v12
    v_mul_f32 v40, 0x41000000, v12
    v_mul_f32 v41, 0x41000000, v13
    v_exp_f32 v40, v40
    v_fract_f32 v41, v41
    v_cos_f32 v42, v41
    v_sin_f32 v43, v41
    v_mul_f32 v20, v40, v42
    v_mul_f32 v21, v40, v43
    v_pk_mul_f32 v[60:61], v[20:21], v[20:21] op_sel:[1,1] op_sel_hi:[1,0] neg_lo:[1,0]
    v_pk_fma_f32 v[22:23], v[20:21], v[20:21], v[60:61] op_sel:[0,0,0] op_sel_hi:[0,1,1]
    s_cmp_ge_u32 s3, 128
    s_cbranch_scc1 L_vnoln_22
    s_mul_i32 s57, s3, 14336
    s_add_u32 s57, s57, 4096
    s_mul_i32 s59, s3, 896
    s_add_u32 s59, s59, 1839104
    s_setprio 3
    s_barrier
    ds_read_b64_tr_b16 v[24:25], v120
    ds_read_b64_tr_b16 v[26:27], v120 offset:9472
    ds_read_b64_tr_b16 v[28:29], v116
    ds_read_b64_tr_b16 v[30:31], v116 offset:9472
    s_waitcnt lgkmcnt(2)
    buffer_store_dwordx4 v[24:27], v121, s[40:43], s57 offen offset:0 sc1
    v_bitop3_b32 v40, v24, v25, v26 bitop3:0x96
    s_waitcnt lgkmcnt(0)
    s_mov_b32 exec_lo, 0xffffffff
    s_mov_b32 exec_hi, 0x0000ffff
    buffer_store_dwordx4 v[28:31], v121, s[40:43], s57 offen offset:1024 sc1
    s_mov_b64 exec, -1
    v_bitop3_b32 v41, v28, v29, v30 bitop3:0x96
    v_xor_b32 v40, v40, v27
    v_xor_b32 v41, v41, v31
    s_nop 0
    v_xor_b32_dpp v40, v40, v40 quad_perm:[1,0,3,2] row_mask:0xf bank_mask:0xf
    v_xor_b32_dpp v41, v41, v41 quad_perm:[1,0,3,2] row_mask:0xf bank_mask:0xf
    s_nop 0
    v_xor_b32_dpp v40, v40, v40 quad_perm:[2,3,0,1] row_mask:0xf bank_mask:0xf
    v_xor_b32_dpp v41, v41, v41 quad_perm:[2,3,0,1] row_mask:0xf bank_mask:0xf
    v_and_b32 v44, 3, v1
    v_cmp_eq_u32 vcc, 1, v44
    s_nop 1
    v_cndmask_b32 v40, v40, v41, vcc
    v_xor_b32 v40, s36, v40
    s_mov_b64 exec, s[64:65]
    buffer_store_dword v40, v122, s[40:43], s59 offen sc1
    s_mov_b64 exec, -1
    s_setprio 0
    s_branch L_vlnj_23
L_vnoln_22:
    s_cmp_eq_u32 s34, 15
    s_cbranch_scc0 L_vlnj_23
    s_lshl_b32 s56, s37, 7
    s_add_u32 s56, s56, 2215936
    v_mov_b32 v30, 0
    v_mov_b32 v31, s36
    s_mov_b64 exec, 1
    buffer_store_dword v31, v30, s[40:43], s56 offen sc1
    s_mov_b64 exec, -1
L_vlnj_23:
    s_lshl_b32 s52, s67, 8
    s_add_u32 s52, s52, 43680
    s_mov_b32 m0, s52
    v_mov_b32 v56, 0x00003f80
    ds_write_addtid_b32 v56
    v_cvt_pk_bf16_f32 v57, v20, v21
    ds_write_addtid_b32 v57 offset:2080
    v_pk_mul_f32 v[60:61], v[20:21], v[22:23] op_sel:[1,1] op_sel_hi:[1,0] neg_lo:[1,0]
    v_pk_fma_f32 v[32:33], v[20:21], v[22:23], v[60:61] op_sel:[0,0,0] op_sel_hi:[0,1,1]
    v_cvt_pk_bf16_f32 v58, v22, v23
    ds_write_addtid_b32 v58 offset:4160
    v_cvt_pk_bf16_f32 v59, v32, v33
    ds_write_addtid_b32 v59 offset:6240
    v_pk_mul_f32 v[62:63], v[22:23], v[22:23] op_sel:[1,1] op_sel_hi:[1,0] neg_lo:[1,0]
    v_pk_fma_f32 v[30:31], v[22:23], v[22:23], v[62:63] op_sel:[0,0,0] op_sel_hi:[0,1,1]
    v_pk_mul_f32 v[60:61], v[32:33], v[22:23] op_sel:[1,1] op_sel_hi:[1,0] neg_lo:[1,0]
    v_pk_fma_f32 v[32:33], v[32:33], v[22:23], v[60:61] op_sel:[0,0,0] op_sel_hi:[0,1,1]
    v_cvt_pk_bf16_f32 v56, v30, v31
    ds_write_addtid_b32 v56 offset:8320
    v_cvt_pk_bf16_f32 v57, v32, v33
    ds_write_addtid_b32 v57 offset:10400
    v_pk_mul_f32 v[62:63], v[30:31], v[22:23] op_sel:[1,1] op_sel_hi:[1,0] neg_lo:[1,0]
    v_pk_fma_f32 v[30:31], v[30:31], v[22:23], v[62:63] op_sel:[0,0,0] op_sel_hi:[0,1,1]
    v_pk_mul_f32 v[60:61], v[32:33], v[22:23] op_sel:[1,1] op_sel_hi:[1,0] neg_lo:[1,0]
    v_pk_fma_f32 v[32:33], v[32:33], v[22:23], v[60:61] op_sel:[0,0,0] op_sel_hi:[0,1,1]
    v_cvt_pk_bf16_f32 v58, v30, v31
    ds_write_addtid_b32 v58 offset:12480
    v_cvt_pk_bf16_f32 v59, v32, v33
    ds_write_addtid_b32 v59 offset:14560
    v_pk_mul_f32 v[62:63], v[30:31], v[22:23] op_sel:[1,1] op_sel_hi:[1,0] neg_lo:[1,0]
    v_pk_fma_f32 v[30:31], v[30:31], v[22:23], v[62:63] op_sel:[0,0,0] op_sel_hi:[0,1,1]
    v_pk_mul_f32 v[60:61], v[32:33], v[22:23] op_sel:[1,1] op_sel_hi:[1,0] neg_lo:[1,0]
    v_pk_fma_f32 v[32:33], v[32:33], v[22:23], v[60:61] op_sel:[0,0,0] op_sel_hi:[0,1,1]
    v_cvt_pk_bf16_f32 v56, v30, v31
    ds_write_addtid_b32 v56 offset:16640
    v_cvt_pk_bf16_f32 v57, v32, v33
    ds_write_addtid_b32 v57 offset:18720
    v_pk_mul_f32 v[62:63], v[30:31], v[22:23] op_sel:[1,1] op_sel_hi:[1,0] neg_lo:[1,0]
    v_pk_fma_f32 v[30:31], v[30:31], v[22:23], v[62:63] op_sel:[0,0,0] op_sel_hi:[0,1,1]
    v_pk_mul_f32 v[60:61], v[32:33], v[22:23] op_sel:[1,1] op_sel_hi:[1,0] neg_lo:[1,0]
    v_pk_fma_f32 v[32:33], v[32:33], v[22:23], v[60:61] op_sel:[0,0,0] op_sel_hi:[0,1,1]
    v_cvt_pk_bf16_f32 v58, v30, v31
    ds_write_addtid_b32 v58 offset:20800
    v_cvt_pk_bf16_f32 v59, v32, v33
    ds_write_addtid_b32 v59 offset:22880
    v_pk_mul_f32 v[62:63], v[30:31], v[22:23] op_sel:[1,1] op_sel_hi:[1,0] neg_lo:[1,0]
    v_pk_fma_f32 v[30:31], v[30:31], v[22:23], v[62:63] op_sel:[0,0,0] op_sel_hi:[0,1,1]
    v_pk_mul_f32 v[60:61], v[32:33], v[22:23] op_sel:[1,1] op_sel_hi:[1,0] neg_lo:[1,0]
    v_pk_fma_f32 v[32:33], v[32:33], v[22:23], v[60:61] op_sel:[0,0,0] op_sel_hi:[0,1,1]
    v_cvt_pk_bf16_f32 v56, v30, v31
    ds_write_addtid_b32 v56 offset:24960
    v_cvt_pk_bf16_f32 v57, v32, v33
    ds_write_addtid_b32 v57 offset:27040
    v_pk_mul_f32 v[62:63], v[30:31], v[22:23] op_sel:[1,1] op_sel_hi:[1,0] neg_lo:[1,0]
    v_pk_fma_f32 v[30:31], v[30:31], v[22:23], v[62:63] op_sel:[0,0,0] op_sel_hi:[0,1,1]
    v_pk_mul_f32 v[60:61], v[32:33], v[22:23] op_sel:[1,1] op_sel_hi:[1,0] neg_lo:[1,0]
    v_pk_fma_f32 v[32:33], v[32:33], v[22:23], v[60:61] op_sel:[0,0,0] op_sel_hi:[0,1,1]
    v_cvt_pk_bf16_f32 v58, v30, v31
    ds_write_addtid_b32 v58 offset:29120
    v_cvt_pk_bf16_f32 v59, v32, v33
    ds_write_addtid_b32 v59 offset:31200
    v_pk_mul_f32 v[62:63], v[30:31], v[22:23] op_sel:[1,1] op_sel_hi:[1,0] neg_lo:[1,0]
    v_pk_fma_f32 v[30:31], v[30:31], v[22:23], v[62:63] op_sel:[0,0,0] op_sel_hi:[0,1,1]
    v_pk_mul_f32 v[60:61], v[32:33], v[22:23] op_sel:[1,1] op_sel_hi:[1,0] neg_lo:[1,0]
    v_pk_fma_f32 v[32:33], v[32:33], v[22:23], v[60:61] op_sel:[0,0,0] op_sel_hi:[0,1,1]
    v_cvt_pk_bf16_f32 v56, v30, v31
    ds_write_addtid_b32 v56 offset:33280
    v_cvt_pk_bf16_f32 v57, v32, v33
    ds_write_addtid_b32 v57 offset:35360
    v_pk_mul_f32 v[62:63], v[30:31], v[22:23] op_sel:[1,1] op_sel_hi:[1,0] neg_lo:[1,0]
    v_pk_fma_f32 v[30:31], v[30:31], v[22:23], v[62:63] op_sel:[0,0,0] op_sel_hi:[0,1,1]
    v_pk_mul_f32 v[60:61], v[32:33], v[22:23] op_sel:[1,1] op_sel_hi:[1,0] neg_lo:[1,0]
    v_pk_fma_f32 v[32:33], v[32:33], v[22:23], v[60:61] op_sel:[0,0,0] op_sel_hi:[0,1,1]
    v_cvt_pk_bf16_f32 v58, v30, v31
    ds_write_addtid_b32 v58 offset:37440
    v_cvt_pk_bf16_f32 v59, v32, v33
    ds_write_addtid_b32 v59 offset:39520
    v_pk_mul_f32 v[62:63], v[30:31], v[22:23] op_sel:[1,1] op_sel_hi:[1,0] neg_lo:[1,0]
    v_pk_fma_f32 v[30:31], v[30:31], v[22:23], v[62:63] op_sel:[0,0,0] op_sel_hi:[0,1,1]
    v_pk_mul_f32 v[60:61], v[32:33], v[22:23] op_sel:[1,1] op_sel_hi:[1,0] neg_lo:[1,0]
    v_pk_fma_f32 v[32:33], v[32:33], v[22:23], v[60:61] op_sel:[0,0,0] op_sel_hi:[0,1,1]
    v_cvt_pk_bf16_f32 v56, v30, v31
    ds_write_addtid_b32 v56 offset:41600
    v_cvt_pk_bf16_f32 v57, v32, v33
    ds_write_addtid_b32 v57 offset:43680
    v_pk_mul_f32 v[62:63], v[30:31], v[22:23] op_sel:[1,1] op_sel_hi:[1,0] neg_lo:[1,0]
    v_pk_fma_f32 v[30:31], v[30:31], v[22:23], v[62:63] op_sel:[0,0,0] op_sel_hi:[0,1,1]
    v_pk_mul_f32 v[60:61], v[32:33], v[22:23] op_sel:[1,1] op_sel_hi:[1,0] neg_lo:[1,0]
    v_pk_fma_f32 v[32:33], v[32:33], v[22:23], v[60:61] op_sel:[0,0,0] op_sel_hi:[0,1,1]
    v_cvt_pk_bf16_f32 v58, v30, v31
    ds_write_addtid_b32 v58 offset:45760
    v_cvt_pk_bf16_f32 v59, v32, v33
    ds_write_addtid_b32 v59 offset:47840
    v_pk_mul_f32 v[62:63], v[30:31], v[22:23] op_sel:[1,1] op_sel_hi:[1,0] neg_lo:[1,0]
    v_pk_fma_f32 v[30:31], v[30:31], v[22:23], v[62:63] op_sel:[0,0,0] op_sel_hi:[0,1,1]
    v_pk_mul_f32 v[60:61], v[32:33], v[22:23] op_sel:[1,1] op_sel_hi:[1,0] neg_lo:[1,0]
    v_pk_fma_f32 v[32:33], v[32:33], v[22:23], v[60:61] op_sel:[0,0,0] op_sel_hi:[0,1,1]
    v_cvt_pk_bf16_f32 v56, v30, v31
    ds_write_addtid_b32 v56 offset:49920
    v_cvt_pk_bf16_f32 v57, v32, v33
    ds_write_addtid_b32 v57 offset:52000
    v_pk_mul_f32 v[62:63], v[30:31], v[22:23] op_sel:[1,1] op_sel_hi:[1,0] neg_lo:[1,0]
    v_pk_fma_f32 v[30:31], v[30:31], v[22:23], v[62:63] op_sel:[0,0,0] op_sel_hi:[0,1,1]
    v_pk_mul_f32 v[60:61], v[32:33], v[22:23] op_sel:[1,1] op_sel_hi:[1,0] neg_lo:[1,0]
    v_pk_fma_f32 v[32:33], v[32:33], v[22:23], v[60:61] op_sel:[0,0,0] op_sel_hi:[0,1,1]
    v_cvt_pk_bf16_f32 v58, v30, v31
    ds_write_addtid_b32 v58 offset:54080
    v_cvt_pk_bf16_f32 v59, v32, v33
    ds_write_addtid_b32 v59 offset:56160
    v_pk_mul_f32 v[62:63], v[30:31], v[22:23] op_sel:[1,1] op_sel_hi:[1,0] neg_lo:[1,0]
    v_pk_fma_f32 v[30:31], v[30:31], v[22:23], v[62:63] op_sel:[0,0,0] op_sel_hi:[0,1,1]
    v_pk_mul_f32 v[60:61], v[32:33], v[22:23] op_sel:[1,1] op_sel_hi:[1,0] neg_lo:[1,0]
    v_pk_fma_f32 v[32:33], v[32:33], v[22:23], v[60:61] op_sel:[0,0,0] op_sel_hi:[0,1,1]
    v_cvt_pk_bf16_f32 v56, v30, v31
    ds_write_addtid_b32 v56 offset:58240
    v_cvt_pk_bf16_f32 v57, v32, v33
    ds_write_addtid_b32 v57 offset:60320
    v_pk_mul_f32 v[62:63], v[30:31], v[22:23] op_sel:[1,1] op_sel_hi:[1,0] neg_lo:[1,0]
    v_pk_fma_f32 v[30:31], v[30:31], v[22:23], v[62:63] op_sel:[0,0,0] op_sel_hi:[0,1,1]
    v_pk_mul_f32 v[60:61], v[32:33], v[22:23] op_sel:[1,1] op_sel_hi:[1,0] neg_lo:[1,0]
    v_pk_fma_f32 v[32:33], v[32:33], v[22:23], v[60:61] op_sel:[0,0,0] op_sel_hi:[0,1,1]
    v_cvt_pk_bf16_f32 v58, v30, v31
    ds_write_addtid_b32 v58 offset:62400
    v_cvt_pk_bf16_f32 v59, v32, v33
    ds_write_addtid_b32 v59 offset:64480
    s_waitcnt lgkmcnt(0)
    s_barrier
    s_lshl_b32 s60, s35, 6
    s_add_u32 s60, s60, 4096
    s_lshl_b32 s62, s35, 2
    s_add_u32 s62, s62, 1839104
    s_mov_b32 s61, 1970176
    buffer_load_dwordx4 v[8:11], v123, s[40:43], s60 offen sc1
    buffer_load_dword v12, v124, s[40:43], s62 offen sc1
    buffer_load_dwordx4 v[16:19], v117, s[40:43], s61 offen sc1
    buffer_load_dwordx4 v[24:27], v117, s[40:43], s61 offen offset:16 sc1
    s_cmp_eq_u32 s2, 0
    s_cbranch_scc0 L_noak_24
    s_cmp_eq_u32 s34, 13
    s_cbranch_scc0 L_noak_24
    s_mov_b32 s56, 2215936
    s_mov_b32 s57, 2224128
    buffer_load_dword v101, v100, s[40:43], s56 offen sc1
    buffer_load_dword v102, v100, s[40:43], s57 offen sc1
L_noak_24:
    s_mov_b32 s58, 0
L_xretry_25:
    s_waitcnt vmcnt(0)
    v_bitop3_b32 v40, v8, v9, v10 bitop3:0x96
    v_xor_b32 v41, s36, v19
    v_xor_b32 v42, s36, v27
    v_xor_b32 v40, v40, v11
    v_or_b32 v41, v41, v42
    s_nop 0
    v_xor_b32_dpp v40, v40, v40 quad_perm:[1,0,3,2] row_mask:0xf bank_mask:0xf
    s_nop 1
    v_xor_b32_dpp v40, v40, v40 quad_perm:[2,3,0,1] row_mask:0xf bank_mask:0xf
    v_bitop3_b32 v40, v40, v12, s36 bitop3:0x96
    v_or_b32 v40, v40, v41
    v_cmp_ne_u32 vcc, 0, v40
    s_cbranch_vccz L_xok_26
    s_add_u32 s58, s58, 1
    s_cmp_ge_u32 s58, 4000
    s_cbranch_scc1 L_xok_26
    buffer_load_dwordx4 v[8:11], v123, s[40:43], s60 offen sc1
    buffer_load_dword v12, v124, s[40:43], s62 offen sc1
    buffer_load_dwordx4 v[16:19], v117, s[40:43], s61 offen sc1
    buffer_load_dwordx4 v[24:27], v117, s[40:43], s61 offen offset:16 sc1
    s_branch L_xretry_25
L_xok_26:
    s_setprio 2
    v_mov_b32 v2, 149576
    ds_read_b32 v3, v2
    v_lshlrev_b32 v28, 16, v16
    v_and_b32 v29, 0xffff0000, v16
    v_lshlrev_b32 v30, 16, v24
    v_and_b32 v31, 0xffff0000, v24
    v_lshlrev_b32 v48, 16, v8
    v_and_b32 v49, 0xffff0000, v8
    v_lshlrev_b32 v50, 16, v9
    v_and_b32 v51, 0xffff0000, v9
    v_lshlrev_b32 v52, 16, v10
    v_and_b32 v53, 0xffff0000, v10
    v_lshlrev_b32 v54, 16, v11
    v_and_b32 v55, 0xffff0000, v11
    v_subrev_f32_dpp v48, v28, v48 quad_perm:[0,0,2,2] row_mask:0xf bank_mask:0xf
    v_subrev_f32_dpp v49, v29, v49 quad_perm:[0,0,2,2] row_mask:0xf bank_mask:0xf
    v_subrev_f32_dpp v50, v30, v50 quad_perm:[0,0,2,2] row_mask:0xf bank_mask:0xf
    v_subrev_f32_dpp v51, v31, v51 quad_perm:[0,0,2,2] row_mask:0xf bank_mask:0xf
    v_subrev_f32_dpp v52, v28, v52 quad_perm:[1,1,3,3] row_mask:0xf bank_mask:0xf
    v_subrev_f32_dpp v53, v29, v53 quad_perm:[1,1,3,3] row_mask:0xf bank_mask:0xf
    v_subrev_f32_dpp v54, v30, v54 quad_perm:[1,1,3,3] row_mask:0xf bank_mask:0xf
    v_subrev_f32_dpp v55, v31, v55 quad_perm:[1,1,3,3] row_mask:0xf bank_mask:0xf
    v_cvt_pk_bf16_f32 v48, 0, v48
    v_cvt_pk_bf16_f32 v49, 0, v49
    v_cvt_pk_bf16_f32 v50, 0, v50
    v_cvt_pk_bf16_f32 v51, 0, v51
    v_cvt_pk_bf16_f32 v52, 0, v52
    v_cvt_pk_bf16_f32 v53, 0, v53
    v_cvt_pk_bf16_f32 v54, 0, v54
    v_cvt_pk_bf16_f32 v55, 0, v55
    v_mul_f32_dpp v48, v17, v48 quad_perm:[0,0,2,2] row_mask:0xf bank_mask:0xf
    v_mul_f32_dpp v49, v18, v49 quad_perm:[0,0,2,2] row_mask:0xf bank_mask:0xf
    v_mul_f32_dpp v50, v25, v50 quad_perm:[0,0,2,2] row_mask:0xf bank_mask:0xf
    v_mul_f32_dpp v51, v26, v51 quad_perm:[0,0,2,2] row_mask:0xf bank_mask:0xf
    v_mul_f32_dpp v52, v17, v52 quad_perm:[1,1,3,3] row_mask:0xf bank_mask:0xf
    v_mul_f32_dpp v53, v18, v53 quad_perm:[1,1,3,3] row_mask:0xf bank_mask:0xf
    v_mul_f32_dpp v54, v25, v54 quad_perm:[1,1,3,3] row_mask:0xf bank_mask:0xf
    v_mul_f32_dpp v55, v26, v55 quad_perm:[1,1,3,3] row_mask:0xf bank_mask:0xf
    v_cvt_pk_bf16_f32 v40, v48, v49
    v_cvt_pk_bf16_f32 v41, v50, v51
    v_cvt_pk_bf16_f32 v42, v52, v53
    v_cvt_pk_bf16_f32 v43, v54, v55
    s_setprio 0
    s_waitcnt lgkmcnt(0)
    v_readfirstlane_b32 s58, v3
    s_nop 0
    s_cmp_ge_u32 s58, 8
    s_cbranch_scc1 L_E_27
    v_mov_b32 v2, 149576
    s_mov_b32 s61, 0
L_spin_28:
    ds_read_b32 v3, v2
    s_waitcnt lgkmcnt(0)
    v_readfirstlane_b32 s58, v3
    s_nop 0
    s_cmp_ge_u32 s58, 8
    s_cbranch_scc1 L_spinx_29
    s_add_u32 s61, s61, 1
    s_cmp_lt_u32 s61, 0x100000
    s_cbranch_scc1 L_spin_28
L_spinx_29:
L_E_27:
    ds_write_b128 v118, v[40:43]
    ds_write_b128 v125, v[8:11]
    s_cmp_eq_u32 s34, 9
    s_cbranch_scc0 L_notail_30
    ds_read_u16 v44, v113
    ds_read_u16 v45, v114
    s_waitcnt lgkmcnt(0)
    v_lshl_or_b32 v44, v45, 16, v44
    ds_write_b32 v115, v44
L_notail_30:
    s_cmp_eq_u32 s34, 8
    s_cbranch_scc0 L_nozero_31
    v_and_b32 v3, 31, v1
    v_lshlrev_b32 v3, 4, v3
    v_add_u32 v50, 4672, v3
    v_cmp_le_u32 vcc, 32, v1
    s_nop 1
    v_cndmask_b32 v3, v3, v50, vcc
    v_mov_b32 v44, 0
    v_mov_b32 v45, 0
    v_mov_b32 v46, 0
    v_mov_b32 v47, 0
    ds_write_b128 v3, v[44:47] offset:0
L_nozero_31:
    s_cmp_lt_u32 s34, 12
    s_cbranch_scc1 L_epi
    s_waitcnt lgkmcnt(0)
    s_barrier
    s_cmp_eq_u32 s2, 0
    s_cbranch_scc0 L_noepoch_32
    s_cmp_eq_u32 s34, 13
    s_cbranch_scc0 L_noepoch_32
    s_mov_b32 s58, 0
L_ack_33:
    v_xor_b32 v101, s36, v101
    v_xor_b32 v102, s36, v102
    v_or_b32 v101, v101, v102
    v_cmp_ne_u32 vcc, 0, v101
    s_cbranch_vccz L_ackok_34
    s_add_u32 s58, s58, 1
    s_cmp_ge_u32 s58, 4000
    s_cbranch_scc1 L_noepoch_32
    buffer_load_dword v101, v100, s[40:43], s56 offen sc1
    buffer_load_dword v102, v100, s[40:43], s57 offen sc1
    s_waitcnt vmcnt(0)
    s_branch L_ack_33
L_ackok_34:
    v_mov_b32 v5, s36
    v_mov_b32 v4, 0
    s_mov_b64 exec, 1
    buffer_store_dword v5, v4, s[40:43], 0 offen offset:0 sc1
L_noepoch_32:
    s_branch L_end
L_epi:
    s_sub_u32 s52, s34, 4
    s_lshr_b32 s68, s52, 2
    s_lshl_b32 s66, s35, 2
    s_lshl_b32 s64, s39, 16
    s_and_b32 s65, s39, 0xffff0000
    s_mov_b32 s69, 0
    s_waitcnt lgkmcnt(0)
    s_barrier
    s_setprio 2
L_epi_loop:
    ds_read_b32 v8, v96 offset:512
    ds_read_b32 v9, v96 offset:5184
    ds_read_b32 v10, v96 offset:9344
    ds_read_b32 v11, v96 offset:13504
    s_waitcnt lgkmcnt(2)
    v_lshlrev_b32 v12, 16, v8
    v_and_b32 v13, 0xffff0000, v8
    v_lshlrev_b32 v14, 16, v9
    v_and_b32 v15, 0xffff0000, v9
    v_mul_f32 v32, 0xbfb8aa3b, v12
    v_mul_f32 v33, 0xbfb8aa3b, v13
    v_mul_f32 v34, 0xbfb8aa3b, v14
    v_mul_f32 v35, 0xbfb8aa3b, v15
    v_mul_f32 v16, s64, v12
    v_mul_f32 v17, s64, v13
    v_mul_f32 v18, s65, v14
    v_mul_f32 v19, s65, v15
    v_exp_f32 v32, v32
    v_exp_f32 v33, v33
    v_exp_f32 v34, v34
    v_exp_f32 v35, v35
    v_cvt_pk_bf16_f32 v16, 0, v16
    v_cvt_pk_bf16_f32 v17, 0, v17
    v_cvt_pk_bf16_f32 v18, 0, v18
    v_cvt_pk_bf16_f32 v19, 0, v19
    v_add_f32 v32, 1.0, v32
    v_add_f32 v33, 1.0, v33
    v_add_f32 v34, 1.0, v34
    v_add_f32 v35, 1.0, v35
    v_rcp_f32 v32, v32
    v_rcp_f32 v33, v33
    v_rcp_f32 v34, v34
    v_rcp_f32 v35, v35
    s_waitcnt lgkmcnt(0)
    v_lshlrev_b32 v28, 16, v10
    v_and_b32 v29, 0xffff0000, v10
    v_lshlrev_b32 v30, 16, v11
    v_and_b32 v31, 0xffff0000, v11
    v_mul_f32 v24, v12, v32
    v_mul_f32 v25, v13, v33
    v_mul_f32 v26, v14, v34
    v_mul_f32 v27, v15, v35
    v_cvt_pk_bf16_f32 v24, 0, v24
    v_cvt_pk_bf16_f32 v25, 0, v25
    v_cvt_pk_bf16_f32 v26, 0, v26
    v_cvt_pk_bf16_f32 v27, 0, v27
    s_sub_u32 s55, s68, s69
    s_cmp_eq_u32 s55, 1
    s_cbranch_scc0 L_b1_35
    s_barrier
L_b1_35:
    s_barrier
    ds_read_b64 v[32:33], v98 offset:0
    ds_read_b64 v[34:35], v98 offset:2048
    ds_read_b64 v[36:37], v98 offset:4096
    ds_read_b64 v[38:39], v98 offset:6144
    s_waitcnt lgkmcnt(2)
    v_pk_add_f32 v[32:33], v[32:33], v[34:35]
    s_waitcnt lgkmcnt(0)
    v_pk_add_f32 v[34:35], v[36:37], v[38:39]
    v_cvt_pk_bf16_f32 v32, 0, v32
    v_cvt_pk_bf16_f32 v33, 0, v33
    v_cvt_pk_bf16_f32 v34, 0, v34
    v_cvt_pk_bf16_f32 v35, 0, v35
    v_pk_add_f32 v[32:33], v[32:33], v[16:17]
    v_pk_add_f32 v[34:35], v[34:35], v[18:19]
    v_cvt_pk_bf16_f32 v32, 0, v32
    v_cvt_pk_bf16_f32 v33, 0, v33
    v_cvt_pk_bf16_f32 v34, 0, v34
    v_cvt_pk_bf16_f32 v35, 0, v35
    v_pk_mul_f32 v[36:37], v[32:33], v[24:25]
    v_pk_mul_f32 v[38:39], v[34:35], v[26:27]
    v_cvt_pk_bf16_f32 v36, 0, v36
    v_cvt_pk_bf16_f32 v37, 0, v37
    v_cvt_pk_bf16_f32 v38, 0, v38
    v_cvt_pk_bf16_f32 v39, 0, v39
    v_pk_add_f32 v[36:37], v[36:37], v[28:29]
    v_pk_add_f32 v[38:39], v[38:39], v[30:31]
    v_cvt_pk_bf16_f32 v40, v36, v38
    v_cvt_pk_bf16_f32 v41, v37, v39
    buffer_store_dword v40, v97, s[44:47], s66 offen
    buffer_store_dword v41, v97, s[44:47], s66 offen offset:896
    v_cvt_pk_bf16_f32 v22, v32, v33
    v_cvt_pk_bf16_f32 v23, v34, v35
    ds_write_b64 v99, v[22:23]
    v_add_u32 v96, 2048, v96
    v_add_u32 v99, 4096, v99
    v_add_u32 v98, 16384, v98
    s_add_u32 s66, s66, 917504
    s_add_u32 s69, s69, 1
    s_add_u32 s55, s68, s69
    s_cmp_eq_u32 s55, 3
    s_cbranch_scc1 L_b3_36
    s_barrier
    s_cmp_lt_u32 s69, 2
    s_cbranch_scc1 L_epi_loop
L_b3_36:
L_epi_done:
    s_waitcnt lgkmcnt(0)
    s_barrier
    v_mov_b32 v6, 149584
    ds_read_b128 v[8:11], v6
    v_and_b32 v16, 1, v1
    s_waitcnt lgkmcnt(0)
    v_readfirstlane_b32 s52, v8
    v_readfirstlane_b32 s53, v9
    v_readfirstlane_b32 s54, v10
    v_readfirstlane_b32 s55, v11
    s_bfe_u32 s58, s52, 0x10009
    s_lshl_b32 s58, s58, 2
    s_bfe_u32 s59, s52, 0x10008
    s_lshl_b32 s59, s59, 1
    s_add_u32 s58, s58, s59
    s_bfe_u32 s59, s52, 0x10001
    s_add_u32 s58, s58, s59
    s_add_u32 s58, s58, 4
    s_cmp_eq_u32 s58, s34
    s_cbranch_scc0 L_fix_37
    s_lshr_b32 s58, s52, 9
    s_lshl_b32 s58, s58, 11
    s_bfe_u32 s59, s52, 0x10008
    s_lshl_b32 s59, s59, 10
    s_add_u32 s58, s58, s59
    s_bfe_u32 s59, s52, 0x10001
    s_lshl_b32 s59, s59, 9
    s_add_u32 s58, s58, s59
    s_bfe_u32 s59, s52, 0x20002
    s_lshl_b32 s59, s59, 7
    s_add_u32 s58, s58, s59
    s_bfe_u32 s59, s52, 0x40004
    s_lshl_b32 s59, s59, 3
    s_add_u32 s58, s58, s59
    s_and_b32 s59, s52, 1
    s_lshl_b32 s59, s59, 1
    s_add_u32 s58, s58, s59
    v_lshl_add_u32 v17, v16, 2, s58
    s_lshl_b32 s59, s52, 1
    v_mul_u32_u24 v18, 4160, v16
    v_add_u32 v18, s59, v18
    ds_read_u16 v20, v17 offset:17664
    ds_read_u16 v21, v18 offset:9344
    s_lshl_b32 s58, s54, 16
    s_and_b32 s59, s54, 0xffff0000
    v_mov_b32 v22, s58
    v_mov_b32 v23, s59
    v_cmp_eq_u32 vcc, 1, v16
    s_nop 1
    v_cndmask_b32 v22, v22, v23, vcc
    s_mul_i32 s63, s52, 896
    s_lshl_b32 s58, s35, 2
    s_add_u32 s63, s63, s58
    s_waitcnt lgkmcnt(0)
    v_lshlrev_b32 v20, 16, v20
    v_lshlrev_b32 v21, 16, v21
    v_mul_f32 v20, v20, v22
    v_cvt_pk_bf16_f32 v20, 0, v20
    v_add_f32 v20, v21, v20
    s_nop 1
    v_mov_b32_dpp v24, v20 quad_perm:[1,0,3,2] row_mask:0xf bank_mask:0xf
    v_cvt_pk_bf16_f32 v20, v20, v24
    v_mov_b32 v25, 0
    s_mov_b64 exec, 1
    buffer_store_dword v20, v25, s[44:47], s63 offen
    s_mov_b64 exec, -1
L_fix_37:
    s_bfe_u32 s58, s53, 0x10009
    s_lshl_b32 s58, s58, 2
    s_bfe_u32 s59, s53, 0x10008
    s_lshl_b32 s59, s59, 1
    s_add_u32 s58, s58, s59
    s_bfe_u32 s59, s53, 0x10001
    s_add_u32 s58, s58, s59
    s_add_u32 s58, s58, 4
    s_cmp_eq_u32 s58, s34
    s_cbranch_scc0 L_fix_38
    s_lshr_b32 s58, s53, 9
    s_lshl_b32 s58, s58, 11
    s_bfe_u32 s59, s53, 0x10008
    s_lshl_b32 s59, s59, 10
    s_add_u32 s58, s58, s59
    s_bfe_u32 s59, s53, 0x10001
    s_lshl_b32 s59, s59, 9
    s_add_u32 s58, s58, s59
    s_bfe_u32 s59, s53, 0x20002
    s_lshl_b32 s59, s59, 7
    s_add_u32 s58, s58, s59
    s_bfe_u32 s59, s53, 0x40004
    s_lshl_b32 s59, s59, 3
    s_add_u32 s58, s58, s59
    s_and_b32 s59, s53, 1
    s_lshl_b32 s59, s59, 1
    s_add_u32 s58, s58, s59
    v_lshl_add_u32 v17, v16, 2, s58
    s_lshl_b32 s59, s53, 1
    v_mul_u32_u24 v18, 4160, v16
    v_add_u32 v18, s59, v18
    ds_read_u16 v20, v17 offset:17664
    ds_read_u16 v21, v18 offset:9344
    s_lshl_b32 s58, s55, 16
    s_and_b32 s59, s55, 0xffff0000
    v_mov_b32 v22, s58
    v_mov_b32 v23, s59
    v_cmp_eq_u32 vcc, 1, v16
    s_nop 1
    v_cndmask_b32 v22, v22, v23, vcc
    s_mul_i32 s63, s53, 896
    s_lshl_b32 s58, s35, 2
    s_add_u32 s63, s63, s58
    s_waitcnt lgkmcnt(0)
    v_lshlrev_b32 v20, 16, v20
    v_lshlrev_b32 v21, 16, v21
    v_mul_f32 v20, v20, v22
    v_cvt_pk_bf16_f32 v20, 0, v20
    v_add_f32 v20, v21, v20
    s_nop 1
    v_mov_b32_dpp v24, v20 quad_perm:[1,0,3,2] row_mask:0xf bank_mask:0xf
    v_cvt_pk_bf16_f32 v20, v20, v24
    v_mov_b32 v25, 0
    s_mov_b64 exec, 1
    buffer_store_dword v20, v25, s[44:47], s63 offen
    s_mov_b64 exec, -1
L_fix_38:
    s_branch L_end
L_moe:
    v_lshlrev_b32 v6, 4, v1
    s_mov_b32 s56, -1
    s_mov_b32 s57, 0x00ffffff
    v_and_b32 v2, 7, v0
    v_lshrrev_b32 v3, 3, v0
    v_mul_u32_u24 v4, 3584, v3
    v_lshl_add_u32 v4, v2, 4, v4
    s_mul_i32 s53, s66, 112
    v_add_u32 v4, s53, v4
    v_mul_u32_u24 v5, 224, v3
    v_lshl_add_u32 v5, v2, 4, v5
    s_mul_i32 s53, s66, 50176
    s_mul_i32 s60, s34, 896
    s_add_u32 s53, s53, s60
    v_add_u32 v7, s53, v6
    s_waitcnt lgkmcnt(0)
    s_load_dword s36, s[32:33], 0
    s_cmp_ge_u32 s34, 14
    s_cbranch_scc1 L_w15_39
    v_cmp_gt_u32 vcc, 7, v2
    s_nop 0
    s_and_b64 s[58:59], exec, vcc
    s_mov_b64 exec, s[58:59]
    global_load_dwordx4 v[80:83], v4, s[22:23]
    global_load_dwordx4 v[96:99], v4, s[24:25]
    v_add_u32 v4, 401408, v4
    global_load_dwordx4 v[84:87], v4, s[22:23]
    global_load_dwordx4 v[100:103], v4, s[24:25]
    v_add_u32 v4, 401408, v4
    global_load_dwordx4 v[88:91], v4, s[22:23]
    global_load_dwordx4 v[104:107], v4, s[24:25]
    v_add_u32 v4, 401408, v4
    global_load_dwordx4 v[92:95], v4, s[22:23]
    global_load_dwordx4 v[108:111], v4, s[24:25]
    s_mov_b64 exec, s[56:57]
    global_load_dwordx4 v[112:115], v7, s[26:27]
    v_add_u32 v7, 12544, v7
    global_load_dwordx4 v[116:119], v7, s[26:27]
    v_add_u32 v7, 12544, v7
    global_load_dwordx4 v[120:123], v7, s[26:27]
    v_add_u32 v7, 12544, v7
    global_load_dwordx4 v[124:127], v7, s[26:27]
    s_mov_b64 exec, -1
    s_mov_b32 s40, s32
    s_and_b32 s41, s33, 0xffff
    s_mov_b32 s42, 0x00221000
    s_mov_b32 s43, 0x00020000
    s_mov_b32 s44, s28
    s_and_b32 s45, s29, 0xffff
    s_mov_b32 s46, 0x001c0000
    s_mov_b32 s47, 0x00020000
    v_add_u32 v8, 51968, v5
    v_add_u32 v9, 102144, v5
    s_mul_i32 s53, s34, 928
    v_add_u32 v77, s53, v6
    s_mov_b64 exec, s[58:59]
    s_waitcnt vmcnt(10)
    ds_write_b128 v8, v[80:83] offset:0
    ds_write_b128 v8, v[96:99] offset:112
    s_waitcnt vmcnt(8)
    ds_write_b128 v8, v[84:87] offset:25088
    ds_write_b128 v8, v[100:103] offset:25200
    s_waitcnt vmcnt(6)
    ds_write_b128 v9, v[88:91] offset:0
    ds_write_b128 v9, v[104:107] offset:112
    s_waitcnt vmcnt(4)
    ds_write_b128 v9, v[92:95] offset:25088
    ds_write_b128 v9, v[108:111] offset:25200
    s_mov_b64 exec, -1
    s_waitcnt lgkmcnt(0)
    s_add_u32 s36, s36, 1
    s_branch L_join_40
L_w15_39:
    s_mov_b32 s40, s32
    s_and_b32 s41, s33, 0xffff
    s_mov_b32 s42, 0x00221000
    s_mov_b32 s43, 0x00020000
    s_mov_b32 s44, s28
    s_and_b32 s45, s29, 0xffff
    s_mov_b32 s46, 0x001c0000
    s_mov_b32 s47, 0x00020000
    s_waitcnt lgkmcnt(0)
    s_add_u32 s36, s36, 1
    s_setprio 3
    s_cmp_eq_u32 s34, 14
    s_cbranch_scc1 L_w14_41
    v_mul_u32_u24 v10, 64, v1
    s_mov_b32 s60, 1953792
    s_mov_b32 s61, 1957888
    s_mov_b32 s62, 0
    buffer_load_dwordx4 v[12:15], v10, s[40:43], s60 offen sc1
    buffer_load_dwordx4 v[16:19], v10, s[40:43], s61 offen sc1
L_rg_43:
    buffer_load_dwordx4 v[20:23], v10, s[40:43], s60 offen sc1
    buffer_load_dwordx4 v[24:27], v10, s[40:43], s61 offen sc1
    s_waitcnt vmcnt(2)
    v_xor_b32 v28, s36, v15
    v_xor_b32 v29, s36, v19
    v_or_b32 v28, v28, v29
    v_cmp_ne_u32 vcc, 0, v28
    s_cbranch_vccz L_rgA_44
    buffer_load_dwordx4 v[12:15], v10, s[40:43], s60 offen sc1
    buffer_load_dwordx4 v[16:19], v10, s[40:43], s61 offen sc1
    s_waitcnt vmcnt(2)
    v_xor_b32 v28, s36, v23
    v_xor_b32 v29, s36, v27
    v_or_b32 v28, v28, v29
    v_cmp_ne_u32 vcc, 0, v28
    s_cbranch_vccz L_rgB_45
    s_add_u32 s62, s62, 1
    s_cmp_lt_u32 s62, 8000
    s_cbranch_scc1 L_rg_43
L_rgB_45:
    v_mov_b32 v32, v20
    v_mov_b32 v33, v21
    v_mov_b32 v36, v24
    v_mov_b32 v37, v25
    s_branch L_rgok_46
L_rgA_44:
    v_mov_b32 v32, v12
    v_mov_b32 v33, v13
    v_mov_b32 v36, v16
    v_mov_b32 v37, v17
L_rgok_46:
    v_min_u32 v40, v32, v36
    v_max_u32 v32, v32, v36
    v_max3_u32 v33, v33, v37, v40
    s_nop 0
    v_mov_b32_dpp v36, v32 quad_perm:[1,0,3,2] row_mask:0xf bank_mask:0xf
    v_mov_b32_dpp v37, v33 quad_perm:[1,0,3,2] row_mask:0xf bank_mask:0xf
    v_min_u32 v40, v32, v36
    v_max_u32 v32, v32, v36
    v_max3_u32 v33, v33, v37, v40
    s_nop 0
    v_mov_b32_dpp v36, v32 quad_perm:[2,3,0,1] row_mask:0xf bank_mask:0xf
    v_mov_b32_dpp v37, v33 quad_perm:[2,3,0,1] row_mask:0xf bank_mask:0xf
    v_min_u32 v40, v32, v36
    v_max_u32 v32, v32, v36
    v_max3_u32 v33, v33, v37, v40
    s_nop 0
    v_mov_b32_dpp v36, v32 row_half_mirror row_mask:0xf bank_mask:0xf
    v_mov_b32_dpp v37, v33 row_half_mirror row_mask:0xf bank_mask:0xf
    v_min_u32 v40, v32, v36
    v_max_u32 v32, v32, v36
    v_max3_u32 v33, v33, v37, v40
    s_nop 0
    v_mov_b32_dpp v36, v32 row_mirror row_mask:0xf bank_mask:0xf
    v_mov_b32_dpp v37, v33 row_mirror row_mask:0xf bank_mask:0xf
    v_min_u32 v40, v32, v36
    v_max_u32 v32, v32, v36
    v_max3_u32 v33, v33, v37, v40
    v_mov_b32 v36, v32
    v_mov_b32 v37, v33
    s_nop 0
    v_permlane16_swap_b32 v32, v36
    v_permlane16_swap_b32 v33, v37
    v_min_u32 v40, v32, v36
    v_max_u32 v32, v32, v36
    v_max3_u32 v33, v33, v37, v40
    v_mov_b32 v36, v32
    v_mov_b32 v37, v33
    s_nop 0
    v_permlane32_swap_b32 v32, v36
    v_permlane32_swap_b32 v33, v37
    v_min_u32 v40, v32, v36
    v_max_u32 v32, v32, v36
    v_max3_u32 v33, v33, v37, v40
    v_readfirstlane_b32 s60, v32
    v_readfirstlane_b32 s61, v33
    s_nop 0
    v_mov_b32 v32, s60
    v_mov_b32 v33, s61
    v_mov_b32 v34, s36
    v_mov_b32 v35, s36
    v_mov_b32 v10, 156160
    s_mov_b64 exec, 1
    ds_write_b128 v10, v[32:35]
    s_mov_b64 exec, -1
    s_waitcnt vmcnt(0)
    s_branch L_keys_42
L_w14_41:
    s_lshl_b32 s60, s37, 7
    s_add_u32 s60, s60, 2215936
    v_mov_b32 v21, 0
    v_mov_b32 v22, s36
    s_mov_b64 exec, 1
    buffer_store_dword v22, v21, s[40:43], s60 offen sc1
    s_mov_b64 exec, -1
    v_mov_b32 v10, 156160
    s_mov_b32 s62, 0
L_spin_47:
    ds_read_b128 v[32:35], v10
    s_waitcnt lgkmcnt(0)
    v_readfirstlane_b32 s58, v34
    v_readfirstlane_b32 s60, v32
    v_readfirstlane_b32 s61, v33
    s_cmp_eq_u32 s58, s36
    s_cbranch_scc1 L_spinx_48
    s_add_u32 s62, s62, 1
    s_cmp_lt_u32 s62, 400000
    s_cbranch_scc1 L_spin_47
L_spinx_48:
L_keys_42:
    s_cmp_eq_u32 s34, 14
    s_cselect_b32 s62, s60, s61
    s_and_b32 s62, s62, 0x7ff
    s_sub_u32 s62, 2047, s62
    s_mul_i32 s64, s62, 896
    v_add_u32 v10, s64, v6
    s_mov_b64 exec, s[56:57]
    global_load_dwordx4 v[12:15], v10, s[4:5]
    s_mov_b64 exec, -1
    s_lshr_b32 s64, s62, 1
    s_lshl_b32 s64, s64, 4
    s_add_u32 s64, s64, 1970176
    s_and_b32 s52, s62, 1
    v_mov_b32 v10, 0
    s_mov_b32 s62, 0
L_st_49:
    buffer_load_dwordx4 v[24:27], v10, s[40:43], s64 offen sc1
    s_waitcnt vmcnt(0)
    v_cmp_ne_u32 vcc, s36, v27
    s_cbranch_vccz L_stok_50
    s_add_u32 s62, s62, 1
    s_cmp_lt_u32 s62, 4000
    s_cbranch_scc1 L_st_49
L_stok_50:
    s_cmp_eq_u32 s52, 0
    s_cselect_b64 vcc, -1, 0
    v_lshlrev_b32 v32, 16, v24
    v_and_b32 v33, 0xffff0000, v24
    v_cndmask_b32 v28, v33, v32, vcc
    v_cndmask_b32 v30, v26, v25, vcc
    v_lshlrev_b32 v36, 16, v12
    v_and_b32 v37, 0xffff0000, v12
    v_lshlrev_b32 v38, 16, v13
    v_and_b32 v39, 0xffff0000, v13
    v_lshlrev_b32 v40, 16, v14
    v_and_b32 v41, 0xffff0000, v14
    v_lshlrev_b32 v42, 16, v15
    v_and_b32 v43, 0xffff0000, v15
    v_pk_add_f32 v[36:37], v[36:37], v[28:29] op_sel_hi:[1,0] neg_lo:[0,1] neg_hi:[0,1]
    v_pk_add_f32 v[38:39], v[38:39], v[28:29] op_sel_hi:[1,0] neg_lo:[0,1] neg_hi:[0,1]
    v_pk_add_f32 v[40:41], v[40:41], v[28:29] op_sel_hi:[1,0] neg_lo:[0,1] neg_hi:[0,1]
    v_pk_add_f32 v[42:43], v[42:43], v[28:29] op_sel_hi:[1,0] neg_lo:[0,1] neg_hi:[0,1]
    v_cvt_pk_bf16_f32 v36, 0, v36
    v_cvt_pk_bf16_f32 v37, 0, v37
    v_cvt_pk_bf16_f32 v38, 0, v38
    v_cvt_pk_bf16_f32 v39, 0, v39
    v_cvt_pk_bf16_f32 v40, 0, v40
    v_cvt_pk_bf16_f32 v41, 0, v41
    v_cvt_pk_bf16_f32 v42, 0, v42
    v_cvt_pk_bf16_f32 v43, 0, v43
    v_pk_mul_f32 v[36:37], v[36:37], v[30:31] op_sel_hi:[1,0]
    v_pk_mul_f32 v[38:39], v[38:39], v[30:31] op_sel_hi:[1,0]
    v_pk_mul_f32 v[40:41], v[40:41], v[30:31] op_sel_hi:[1,0]
    v_pk_mul_f32 v[42:43], v[42:43], v[30:31] op_sel_hi:[1,0]
    v_cvt_pk_bf16_f32 v12, v36, v37
    v_cvt_pk_bf16_f32 v13, v38, v39
    v_cvt_pk_bf16_f32 v14, v40, v41
    v_cvt_pk_bf16_f32 v15, v42, v43
    v_lshrrev_b32 v10, 2, v1
    v_lshlrev_b32 v10, 6, v10
    v_and_b32 v11, 1, v1
    v_lshl_add_u32 v10, v11, 5, v10
    v_bfe_u32 v11, v1, 1, 1
    v_lshl_add_u32 v10, v11, 3, v10
    s_sub_u32 s53, s34, 14
    s_mul_i32 s53, s53, 896
    s_add_u32 s53, s53, 152320
    v_add_u32 v10, s53, v10
    s_mov_b64 exec, s[56:57]
    ds_write2_b64 v10, v[12:13], v[14:15] offset0:0 offset1:2
    s_mov_b64 exec, -1
L_join_40:
    v_lshrrev_b32 v2, 4, v1
    v_and_b32 v3, 15, v1
    v_lshrrev_b32 v4, 2, v3
    v_lshl_add_u32 v4, v2, 2, v4
    v_and_b32 v5, 3, v1
    v_lshlrev_b32 v5, 3, v5
    v_mul_u32_u24 v11, 224, v4
    v_add_u32 v11, v11, v5
    s_cmp_ge_u32 s34, 7
    s_cselect_b32 s67, 1, 0
    s_mul_i32 s68, s67, 7
    s_sub_u32 s68, s34, s68
    s_lshl_b32 s53, s68, 5
    s_mul_i32 s69, s67, 50176
    s_add_u32 s53, s53, s69
    s_add_u32 s53, s53, 51968
    v_add_u32 v11, s53, v11
    s_lshl_b32 s69, s68, 6
    s_mul_i32 s53, s67, 896
    s_add_u32 s69, s69, s53
    s_add_u32 s69, s69, 154112
    s_lshl_b32 s52, s34, 5
    v_mul_u32_u24 v13, 928, v4
    v_add_u32 v13, v13, v5
    s_add_u32 s53, s52, 0
    v_add_u32 v13, s53, v13
    v_and_b32 v5, 1, v1
    v_mul_u32_u24 v14, 896, v5
    v_lshl_add_u32 v14, v2, 4, v14
    s_mul_i32 s53, s67, 448
    s_add_u32 s53, s53, 152320
    v_add_u32 v14, s53, v14
    v_lshlrev_b32 v15, 7, v5
    v_lshl_add_u32 v15, v2, 3, v15
    v_add_u32 v15, 155904, v15
    v_lshlrev_b32 v7, 4, v1
    s_waitcnt lgkmcnt(0)
    s_barrier
    s_cmp_ge_u32 s34, 14
    s_cbranch_scc1 L_nogu_51
    ds_read_b64_tr_b16 v[44:45], v11 offset:0
    ds_read_b64_tr_b16 v[46:47], v11 offset:3584
    ds_read_b128 v[16:19], v14 offset:0
    ds_read_b64_tr_b16 v[48:49], v11 offset:7168
    ds_read_b64_tr_b16 v[50:51], v11 offset:10752
    ds_read_b128 v[20:23], v14 offset:64
    ds_read_b64_tr_b16 v[52:53], v11 offset:14336
    ds_read_b64_tr_b16 v[54:55], v11 offset:17920
    ds_read_b128 v[24:27], v14 offset:128
    ds_read_b64_tr_b16 v[56:57], v11 offset:21504
    ds_read_b64_tr_b16 v[58:59], v11 offset:25088
    ds_read_b128 v[28:31], v14 offset:192
    ds_read_b64_tr_b16 v[60:61], v11 offset:28672
    ds_read_b64_tr_b16 v[62:63], v11 offset:32256
    ds_read_b128 v[32:35], v14 offset:256
    s_waitcnt lgkmcnt(12)
    v_mfma_f32_16x16x32_bf16 v[72:75], v[16:19], v[44:47], 0
    ds_read_b64_tr_b16 v[64:65], v11 offset:35840
    ds_read_b64_tr_b16 v[66:67], v11 offset:39424
    ds_read_b128 v[36:39], v14 offset:320
    s_waitcnt lgkmcnt(12)
    v_mfma_f32_16x16x32_bf16 v[72:75], v[20:23], v[48:51], v[72:75]
    ds_read_b64_tr_b16 v[68:69], v11 offset:43008
    ds_read_b64_tr_b16 v[70:71], v11 offset:46592
    ds_read_b128 v[40:43], v14 offset:384
    s_waitcnt lgkmcnt(12)
    v_mfma_f32_16x16x32_bf16 v[72:75], v[24:27], v[52:55], v[72:75]
    s_waitcnt lgkmcnt(9)
    v_mfma_f32_16x16x32_bf16 v[72:75], v[28:31], v[56:59], v[72:75]
    s_waitcnt lgkmcnt(6)
    v_mfma_f32_16x16x32_bf16 v[72:75], v[32:35], v[60:63], v[72:75]
    s_waitcnt lgkmcnt(3)
    v_mfma_f32_16x16x32_bf16 v[72:75], v[36:39], v[64:67], v[72:75]
    s_waitcnt lgkmcnt(0)
    v_mfma_f32_16x16x32_bf16 v[72:75], v[40:43], v[68:71], v[72:75]
    v_lshl_add_u32 v10, v1, 2, s69
    s_mov_b64 exec, 0xffff
    s_nop 5
    ds_write_b32 v10, v72
    ds_write_b32 v10, v73 offset:448
    s_mov_b64 exec, -1
L_nogu_51:
    s_waitcnt lgkmcnt(0)
    s_barrier
    s_cmp_ge_u32 s34, 14
    s_cbranch_scc1 L_nodw_53
    s_waitcnt vmcnt(0)
    s_mov_b64 exec, s[56:57]
    ds_write_b128 v77, v[112:115] offset:0
    ds_write_b128 v77, v[116:119] offset:12992
    ds_write_b128 v77, v[120:123] offset:25984
    ds_write_b128 v77, v[124:127] offset:38976
    s_mov_b64 exec, -1
L_nodw_53:
    s_cmp_eq_u32 s34, 14
    s_cbranch_scc0 L_noh_52
    v_lshlrev_b32 v10, 2, v1
    v_add_u32 v10, 154112, v10
    ds_read_b32 v16, v10 offset:0
    ds_read_b32 v24, v10 offset:896
    ds_read_b32 v17, v10 offset:448
    ds_read_b32 v25, v10 offset:1344
    ds_read_b32 v18, v10 offset:224
    ds_read_b32 v26, v10 offset:1120
    ds_read_b32 v19, v10 offset:672
    ds_read_b32 v27, v10 offset:1568
    v_lshlrev_b32 v10, 1, v1
    v_add_u32 v10, 155904, v10
    v_cmp_gt_u32 vcc, 56, v1
    s_waitcnt lgkmcnt(0)
    v_add_f32 v16, v16, v24
    v_add_f32 v17, v17, v25
    v_add_f32 v18, v18, v26
    v_add_f32 v19, v19, v27
    v_cvt_pk_bf16_f32 v16, 0, v16
    v_cvt_pk_bf16_f32 v17, 0, v17
    v_cvt_pk_bf16_f32 v18, 0, v18
    v_cvt_pk_bf16_f32 v19, 0, v19
    v_mul_f32 v20, 0xbfb8aa3b, v16
    v_mul_f32 v21, 0xbfb8aa3b, v17
    v_exp_f32 v20, v20
    v_exp_f32 v21, v21
    v_add_f32 v20, 1.0, v20
    v_add_f32 v21, 1.0, v21
    v_rcp_f32 v20, v20
    v_rcp_f32 v21, v21
    v_mul_f32 v20, v16, v20
    v_mul_f32 v21, v17, v21
    v_cvt_pk_bf16_f32 v20, 0, v20
    v_cvt_pk_bf16_f32 v21, 0, v21
    v_mul_f32 v20, v20, v18
    v_mul_f32 v21, v21, v19
    v_cvt_pk_bf16_f32 v20, v20, v21
    v_cndmask_b32 v20, 0, v20, vcc
    ds_write_b16 v10, v20
    ds_write_b16_d16_hi v10, v20 offset:128
L_noh_52:
    s_waitcnt lgkmcnt(0)
    s_barrier
    s_cmp_ge_u32 s34, 14
    s_cbranch_scc1 L_nodn_54
    ds_read_b64 v[16:17], v15 offset:0
    ds_read_b64 v[18:19], v15 offset:32
    ds_read_b64 v[20:21], v15 offset:64
    ds_read_b64 v[22:23], v15 offset:96
    v_mov_b32 v10, 156160
    ds_read_b64 v[24:25], v10
    ds_read_b64_tr_b16 v[32:33], v13 offset:0
    ds_read_b64_tr_b16 v[34:35], v13 offset:14848
    ds_read_b64_tr_b16 v[36:37], v13 offset:29696
    ds_read_b64_tr_b16 v[38:39], v13 offset:44544
    ds_read_b64_tr_b16 v[40:41], v13 offset:448
    ds_read_b64_tr_b16 v[42:43], v13 offset:15296
    ds_read_b64_tr_b16 v[44:45], v13 offset:30144
    ds_read_b64_tr_b16 v[46:47], v13 offset:44992
    s_mul_i32 s52, s66, 7168
    s_lshl_b32 s53, s34, 8
    s_add_u32 s52, s52, s53
    s_add_u32 s52, s52, 1986560
    v_and_b32 v6, 1, v1
    v_cmp_eq_u32 vcc, 1, v6
    v_mov_b32 v59, s36
    v_mov_b32 v63, s36
    s_waitcnt lgkmcnt(4)
    v_cndmask_b32 v58, v24, v25, vcc
    v_cndmask_b32 v62, v24, v25, vcc
    v_mfma_f32_16x16x32_bf16 v[48:51], v[16:19], v[32:35], 0
    v_mfma_f32_16x16x32_bf16 v[48:51], v[20:23], v[36:39], v[48:51]
    s_waitcnt lgkmcnt(0)
    v_mfma_f32_16x16x32_bf16 v[52:55], v[16:19], v[40:43], 0
    v_mfma_f32_16x16x32_bf16 v[52:55], v[20:23], v[44:47], v[52:55]
    s_add_u32 s53, s52, 3584
    s_nop 3
    v_mov_b32 v56, v48
    v_mov_b32 v57, v49
    s_mov_b64 exec, 0xffff
    buffer_store_dwordx4 v[56:59], v7, s[40:43], s52 offen sc1
    s_mov_b64 exec, -1
    v_mov_b32 v60, v52
    v_mov_b32 v61, v53
    s_mov_b64 exec, 0xffff
    buffer_store_dwordx4 v[60:63], v7, s[40:43], s53 offen sc1
    s_mov_b64 exec, -1
L_nodn_54:
L_end:
    s_endpgm
L_code_end:

.section .rodata,"a"
.p2align 6
.amdhsa_kernel recurrent_scan__ssm_conv_s4d__moe_arch_mod__prompt_kernel
  .amdhsa_next_free_vgpr 128
  .amdhsa_next_free_sgpr 102
  .amdhsa_accum_offset 128
  .amdhsa_group_segment_fixed_size 0
  .amdhsa_kernarg_size 120
  .amdhsa_user_sgpr_count 2
  .amdhsa_user_sgpr_kernarg_segment_ptr 1
  .amdhsa_system_sgpr_workgroup_id_x 1
.end_amdhsa_kernel
```
